```python
import torch

def _softmax(x, axis=-1):
    return torch.softmax(x, dim=axis)
def _gelu(x):
    return torch.nn.functional.gelu(x, approximate="tanh")
def _silu(x):
    return torch.nn.functional.silu(x)
def _sigmoid(x):
    return torch.sigmoid(x)
def _layernorm(x, axis=-1, eps=1e-5):
    m = x.mean(dim=axis, keepdim=True)
    v = x.var(dim=axis, keepdim=True, unbiased=False)
    return (x - m) / torch.sqrt(v + eps)
def _scatter_add(tgt, idx, src, axis=0):
    return tgt.clone().index_add_(axis, idx, src)
def _segment_sum(src, seg, n):
    out = torch.zeros((n,) + src.shape[1:], dtype=src.dtype)
    return out.index_add_(0, seg, src)
def _pad(x, pw):
    flat = tuple(v for pair in reversed(pw) for v in pair)
    return torch.nn.functional.pad(x, flat)

kernel_name = 'concat_heads__gqa_block_cached__gqa_block_cached__near_ridge'

def setup_inputs():

    _w = (lambda a: (lambda t: t.to(torch.bfloat16) if t.is_floating_point() else t)(torch.as_tensor(a)))
    def _A_setup():
        B, Sq, D = 8, 64, 448
        Hq, Hkv, Sk, Dh = 16, 8, 512, 256
        assert Hq % Hkv == 0, (Hq, Hkv)
        return {
            "x": _w((lambda *s: torch.randn(*s, dtype=torch.bfloat16) * 0.8)(B, Sq, D)),
            "k_cache": _w((lambda *s: torch.randn(*s, dtype=torch.bfloat16) * 0.8)(B, Hkv, Sk, Dh)),
            "v_cache": _w((lambda *s: torch.randn(*s, dtype=torch.bfloat16) * 0.05)(B, Hkv, Sk, Dh)),
            "wq": _w((lambda *s: torch.randn(*s, dtype=torch.bfloat16) * 0.8)(D, Hq * Dh) * (D ** -0.5)),
            "wo": _w((lambda *s: torch.randn(*s, dtype=torch.bfloat16) * 0.05)(Hq * Dh, D) * ((Hq * Dh) ** -0.5)),
        }
    _A_in = _A_setup()

    def _B_setup():
        B, Sq, D = 8, 64, 448
        Hq, Hkv, Sk, Dh = 16, 8, 512, 256
        assert Hq % Hkv == 0, (Hq, Hkv)
        return {
            "x": _w((lambda *s: torch.randn(*s, dtype=torch.bfloat16) * 0.8)(B, Sq, D)),
            "k_cache": _w((lambda *s: torch.randn(*s, dtype=torch.bfloat16) * 0.8)(B, Hkv, Sk, Dh)),
            "v_cache": _w((lambda *s: torch.randn(*s, dtype=torch.bfloat16) * 0.05)(B, Hkv, Sk, Dh)),
            "wq": _w((lambda *s: torch.randn(*s, dtype=torch.bfloat16) * 0.8)(D, Hq * Dh) * (D ** -0.5)),
            "wo": _w((lambda *s: torch.randn(*s, dtype=torch.bfloat16) * 0.05)(Hq * Dh, D) * ((Hq * Dh) ** -0.5)),
        }
    _B_in = _B_setup()

    return {
        "A_x": _A_in["x"],
        "A_k_cache": _A_in["k_cache"],
        "A_v_cache": _A_in["v_cache"],
        "A_wq": _A_in["wq"],
        "A_wo": _A_in["wo"],
        "B_x": _B_in["x"],
        "B_k_cache": _B_in["k_cache"],
        "B_v_cache": _B_in["v_cache"],
        "B_wq": _B_in["wq"],
        "B_wo": _B_in["wo"],
    }

def reference(A_x, A_k_cache, A_v_cache, A_wq, A_wo, B_x, B_k_cache, B_v_cache, B_wq, B_wo):
    def _A_ref(x, k_cache, v_cache, wq, wo):
        B, Sq, D = x.shape
        Hq, Dh = 16, 256
        Hkv = k_cache.shape[1]
        rep = Hq // Hkv
        q = (lambda x, *d: x.permute(*d))((x @ wq).reshape(B, Sq, Hq, Dh), 0, 2, 1, 3)
        k = (lambda x, n, axis: torch.repeat_interleave(x, n, dim=axis))(k_cache, rep, axis=1)
        v = (lambda x, n, axis: torch.repeat_interleave(x, n, dim=axis))(v_cache, rep, axis=1)
        scores = torch.einsum("bhqd,bhkd->bhqk", q, k) * (Dh ** -0.5)
        p = _softmax(scores, axis=-1)
        o = torch.einsum("bhqk,bhkd->bhqd", p, v)
        return (lambda x, *d: x.permute(*d))(o, 0, 2, 1, 3).reshape(B, Sq, Hq * Dh) @ wo

    def _B_ref(x, k_cache, v_cache, wq, wo):
        B, Sq, D = x.shape
        Hq, Dh = 16, 256
        Hkv = k_cache.shape[1]
        rep = Hq // Hkv
        q = (lambda x, *d: x.permute(*d))((x @ wq).reshape(B, Sq, Hq, Dh), 0, 2, 1, 3)
        k = (lambda x, n, axis: torch.repeat_interleave(x, n, dim=axis))(k_cache, rep, axis=1)
        v = (lambda x, n, axis: torch.repeat_interleave(x, n, dim=axis))(v_cache, rep, axis=1)
        scores = torch.einsum("bhqd,bhkd->bhqk", q, k) * (Dh ** -0.5)
        p = _softmax(scores, axis=-1)
        o = torch.einsum("bhqk,bhkd->bhqd", p, v)
        return (lambda x, *d: x.permute(*d))(o, 0, 2, 1, 3).reshape(B, Sq, Hq * Dh) @ wo

    a = _A_ref(A_x, A_k_cache, A_v_cache, A_wq, A_wo)
    b = _B_ref(B_x, B_k_cache, B_v_cache, B_wq, B_wo)
    return torch.concatenate([a, b], axis=-1)
```

```asm
; @launch kernel=concat_heads__gqa_block_cached__gqa_block_cached__near_ridge_kernel grid=(256,1,1) block=(256,1,1) lds=163840
; @launch kernel=reduce_partials_kernel grid=(896,1,1) block=(64,1,1) lds=0
.amdgcn_target "amdgcn-amd-amdhsa--gfx950"
.text
.globl concat_heads__gqa_block_cached__gqa_block_cached__near_ridge_kernel
.p2align 8
.type concat_heads__gqa_block_cached__gqa_block_cached__near_ridge_kernel,@function
concat_heads__gqa_block_cached__gqa_block_cached__near_ridge_kernel:
    s_cmp_ge_u32 s2, 256
    s_cbranch_scc1 K1_END
    s_load_dwordx16 s[36:51], s[0:1], 0
    s_load_dwordx8 s[52:59], s[0:1], 64
    s_load_dwordx2 s[60:61], s[0:1], 96
    s_getpc_b64 s[62:63]
K1_PC:
    v_lshlrev_b32 v48, 7, v0
    v_min_u32 v50, CODE_END-K1_PC-4, v48
    global_load_dword a254, v50, s[62:63]
    v_add_u32 v48, 0x8000, v48
    v_min_u32 v50, CODE_END-K1_PC-4, v48
    global_load_dword a253, v50, s[62:63]
    v_and_b32 v1, 63, v0
    v_lshrrev_b32 v51, 6, v0
    s_nop 0
    v_readfirstlane_b32 s4, v51
    s_and_b32 s64, s2, 7
    s_lshr_b32 s65, s2, 3
    s_lshr_b32 s66, s65, 4
    s_lshl_b32 s64, s64, 1
    s_add_u32 s64, s64, s66
    s_lshr_b32 s34, s64, 3
    s_and_b32 s35, s64, 7
    s_lshr_b32 s32, s65, 1
    s_and_b32 s32, s32, 7
    s_and_b32 s66, s65, 1
    s_lshl_b32 s33, s35, 1
    s_add_u32 s33, s33, s66
    s_mul_i32 s5, s4, 24576
    s_add_u32 s5, s5, 65536
    s_cmp_eq_u32 s32, 7
    s_cselect_b32 s64, 3, s32
    s_add_u32 s65, s64, 0
    s_sub_u32 s66, s65, 7
    s_cmp_ge_u32 s65, 7
    s_cselect_b32 s65, s66, s65
    s_lshl_b32 s80, s65, 19
    s_add_u32 s65, s64, 1
    s_sub_u32 s66, s65, 7
    s_cmp_ge_u32 s65, 7
    s_cselect_b32 s65, s66, s65
    s_lshl_b32 s81, s65, 19
    s_add_u32 s65, s64, 2
    s_sub_u32 s66, s65, 7
    s_cmp_ge_u32 s65, 7
    s_cselect_b32 s65, s66, s65
    s_lshl_b32 s82, s65, 19
    s_add_u32 s65, s64, 3
    s_sub_u32 s66, s65, 7
    s_cmp_ge_u32 s65, 7
    s_cselect_b32 s65, s66, s65
    s_lshl_b32 s83, s65, 19
    s_add_u32 s65, s64, 4
    s_sub_u32 s66, s65, 7
    s_cmp_ge_u32 s65, 7
    s_cselect_b32 s65, s66, s65
    s_lshl_b32 s84, s65, 19
    s_add_u32 s65, s64, 5
    s_sub_u32 s66, s65, 7
    s_cmp_ge_u32 s65, 7
    s_cselect_b32 s65, s66, s65
    s_lshl_b32 s85, s65, 19
    s_add_u32 s65, s64, 6
    s_sub_u32 s66, s65, 7
    s_cmp_ge_u32 s65, 7
    s_cselect_b32 s65, s66, s65
    s_lshl_b32 s86, s65, 19
    v_lshrrev_b32 v52, 3, v1
    v_and_b32 v53, 7, v1
    v_lshrrev_b32 v54, 4, v1
    s_lshl_b32 s67, s4, 7
    s_mul_i32 s64, s4, 14336
    v_mul_u32_u24 v56, 896, v52
    v_add_u32 v56, s64, v56
    v_xor_b32 v57, v53, v54
    v_lshl_add_u32 v2, v57, 4, v56
    v_xor_b32 v58, 4, v57
    v_lshl_add_u32 v3, v58, 4, v56
    v_add_u32 v3, 7168, v3
    s_lshl_b32 s64, s4, 16
    v_lshl_add_u32 v56, v52, 9, s64
    v_lshl_add_u32 v8, v57, 4, v56
    v_lshl_add_u32 v9, v58, 4, v56
    v_add_u32 v9, 3072, v9
    v_lshl_add_u32 v10, v57, 4, v56
    v_add_u32 v10, 6144, v10
    v_lshl_add_u32 v11, v58, 4, v56
    v_add_u32 v11, 9216, v11
    v_and_b32 v59, 1, v54
    v_lshlrev_b32 v59, 2, v59
    v_xor_b32 v59, v53, v59
    v_lshl_add_u32 v59, v59, 4, s67
    v_lshl_add_u32 v4, v52, 13, v59
    v_lshl_add_u32 v12, v52, 9, v59
    v_add_u32 v5, 64512, v4
    v_add_u32 v13, 3072, v12
    v_add_u32 v6, 129024, v4
    v_add_u32 v14, 6144, v12
    v_add_u32 v7, 193536, v4
    v_add_u32 v15, 9216, v12
    s_waitcnt lgkmcnt(0)
    s_cmp_eq_u32 s34, 0
    s_cselect_b64 s[36:37], s[36:37], s[46:47]
    s_cselect_b64 s[38:39], s[38:39], s[48:49]
    s_cselect_b64 s[40:41], s[40:41], s[50:51]
    s_cselect_b64 s[42:43], s[42:43], s[52:53]
    s_cselect_b64 s[44:45], s[44:45], s[54:55]
    s_mul_i32 s64, s32, 57344
    s_add_u32 s8, s36, s64
    s_addc_u32 s9, s37, 0
    s_and_b32 s9, s9, 0xffff
    s_mov_b32 s10, 57344
    s_mov_b32 s11, 0x00020000
    s_lshl_b32 s64, s33, 9
    s_add_u32 s12, s42, s64
    s_addc_u32 s13, s43, 0
    s_and_b32 s13, s13, 0xffff
    s_sub_u32 s14, 3670016, s64
    s_mov_b32 s15, 0x00020000
    s_lshl_b32 s64, s32, 3
    s_add_u32 s64, s64, s35
    s_lshl_b32 s64, s64, 18
    s_add_u32 s16, s38, s64
    s_addc_u32 s17, s39, 0
    s_and_b32 s17, s17, 0xffff
    s_mov_b32 s18, 262144
    s_mov_b32 s19, 0x00020000
    s_add_u32 s20, s40, s64
    s_addc_u32 s21, s41, 0
    s_and_b32 s21, s21, 0xffff
    s_mov_b32 s22, 262144
    s_mov_b32 s23, 0x00020000
    s_lshl_b32 s64, s4, 11
    s_mul_i32 s65, s33, 37
    s_lshr_b32 s65, s65, 8
    s_mul_i32 s65, s65, 7
    s_sub_u32 s65, s33, s65
    s_lshr_b32 s66, s80, 19
    s_add_u32 s66, s66, s65
    s_sub_u32 s67, s66, 7
    s_cmp_ge_u32 s66, 7
    s_cselect_b32 s66, s67, s66
    s_lshl_b32 s6, s66, 7
    s_lshl_b32 s67, s65, 13
    s_add_u32 m0, s67, s64
    s_nop 0
    buffer_load_dwordx4 v2, s[8:11], s6 offen lds
    s_add_u32 m0, m0, 1024
    s_add_u32 s65, s65, 1
    s_cmp_eq_u32 s65, 7
    s_cselect_b32 s65, 0, s65
    buffer_load_dwordx4 v3, s[8:11], s6 offen lds
    s_add_u32 s66, s66, 1
    s_cmp_eq_u32 s66, 7
    s_cselect_b32 s66, 0, s66
    s_lshl_b32 s6, s66, 7
    s_lshl_b32 s67, s65, 13
    s_add_u32 m0, s67, s64
    s_nop 0
    buffer_load_dwordx4 v2, s[8:11], s6 offen lds
    s_add_u32 m0, m0, 1024
    s_add_u32 s65, s65, 1
    s_cmp_eq_u32 s65, 7
    s_cselect_b32 s65, 0, s65
    buffer_load_dwordx4 v3, s[8:11], s6 offen lds
    s_add_u32 s66, s66, 1
    s_cmp_eq_u32 s66, 7
    s_cselect_b32 s66, 0, s66
    s_lshl_b32 s6, s66, 7
    s_lshl_b32 s67, s65, 13
    s_add_u32 m0, s67, s64
    s_nop 0
    buffer_load_dwordx4 v2, s[8:11], s6 offen lds
    s_add_u32 m0, m0, 1024
    s_add_u32 s65, s65, 1
    s_cmp_eq_u32 s65, 7
    s_cselect_b32 s65, 0, s65
    buffer_load_dwordx4 v3, s[8:11], s6 offen lds
    s_add_u32 s66, s66, 1
    s_cmp_eq_u32 s66, 7
    s_cselect_b32 s66, 0, s66
    s_lshl_b32 s6, s66, 7
    s_lshl_b32 s67, s65, 13
    s_add_u32 m0, s67, s64
    s_nop 0
    buffer_load_dwordx4 v2, s[8:11], s6 offen lds
    s_add_u32 m0, m0, 1024
    s_add_u32 s65, s65, 1
    s_cmp_eq_u32 s65, 7
    s_cselect_b32 s65, 0, s65
    buffer_load_dwordx4 v3, s[8:11], s6 offen lds
    s_add_u32 s66, s66, 1
    s_cmp_eq_u32 s66, 7
    s_cselect_b32 s66, 0, s66
    s_lshl_b32 s6, s66, 7
    s_lshl_b32 s67, s65, 13
    s_add_u32 m0, s67, s64
    s_nop 0
    buffer_load_dwordx4 v2, s[8:11], s6 offen lds
    s_add_u32 m0, m0, 1024
    s_add_u32 s65, s65, 1
    s_cmp_eq_u32 s65, 7
    s_cselect_b32 s65, 0, s65
    buffer_load_dwordx4 v3, s[8:11], s6 offen lds
    s_add_u32 s66, s66, 1
    s_cmp_eq_u32 s66, 7
    s_cselect_b32 s66, 0, s66
    s_lshl_b32 s6, s66, 7
    s_lshl_b32 s67, s65, 13
    s_add_u32 m0, s67, s64
    s_nop 0
    buffer_load_dwordx4 v2, s[8:11], s6 offen lds
    s_add_u32 m0, m0, 1024
    s_add_u32 s65, s65, 1
    s_cmp_eq_u32 s65, 7
    s_cselect_b32 s65, 0, s65
    buffer_load_dwordx4 v3, s[8:11], s6 offen lds
    s_add_u32 s66, s66, 1
    s_cmp_eq_u32 s66, 7
    s_cselect_b32 s66, 0, s66
    s_lshl_b32 s6, s66, 7
    s_lshl_b32 s67, s65, 13
    s_add_u32 m0, s67, s64
    s_nop 0
    buffer_load_dwordx4 v2, s[8:11], s6 offen lds
    s_add_u32 m0, m0, 1024
    s_nop 0
    buffer_load_dwordx4 v3, s[8:11], s6 offen lds
    s_add_u32 m0, s5, 0
    s_add_u32 s6, s80, 0
    buffer_load_dwordx4 v4, s[12:15], s6 offen lds
    buffer_load_dwordx4 v5, s[12:15], s6 offen offset:1024 lds
    buffer_load_dwordx4 v6, s[12:15], s6 offen offset:2048 lds
    buffer_load_dwordx4 v7, s[12:15], s6 offen offset:3072 lds
    s_add_u32 m0, s5, 4096
    s_add_u32 s6, s80, 262144
    buffer_load_dwordx4 v4, s[12:15], s6 offen lds
    buffer_load_dwordx4 v5, s[12:15], s6 offen offset:1024 lds
    buffer_load_dwordx4 v6, s[12:15], s6 offen offset:2048 lds
    buffer_load_dwordx4 v7, s[12:15], s6 offen offset:3072 lds
    s_add_u32 m0, s5, 8192
    s_add_u32 s6, s81, 0
    buffer_load_dwordx4 v4, s[12:15], s6 offen lds
    buffer_load_dwordx4 v5, s[12:15], s6 offen offset:1024 lds
    buffer_load_dwordx4 v6, s[12:15], s6 offen offset:2048 lds
    buffer_load_dwordx4 v7, s[12:15], s6 offen offset:3072 lds
    s_add_u32 m0, s5, 12288
    s_add_u32 s6, s81, 262144
    buffer_load_dwordx4 v4, s[12:15], s6 offen lds
    buffer_load_dwordx4 v5, s[12:15], s6 offen offset:1024 lds
    buffer_load_dwordx4 v6, s[12:15], s6 offen offset:2048 lds
    buffer_load_dwordx4 v7, s[12:15], s6 offen offset:3072 lds
    s_mov_b32 s7, 0x3db8aa3b
    s_mul_i32 s64, s33, 229376
    s_add_u32 s24, s44, s64
    s_addc_u32 s25, s45, 0
    s_and_b32 s25, s25, 0xffff
    s_mov_b32 s26, 229376
    s_mov_b32 s27, 0x00020000
    s_lshl_b32 s64, s34, 3
    s_add_u32 s64, s64, s32
    s_lshl_b32 s64, s64, 4
    s_add_u32 s64, s64, s33
    s_mul_i32 s65, s64, 57344
    s_add_u32 s28, s60, s65
    s_addc_u32 s29, s61, 0
    s_and_b32 s29, s29, 0xffff
    s_mov_b32 s30, 57344
    s_mov_b32 s31, 0x00020000
    s_mov_b32 s68, 0
    s_mov_b32 s69, 4096
    s_mov_b32 s70, 8192
    s_mov_b32 s71, 12288
    s_mov_b32 s78, s32
    s_add_u32 s65, s78, 0
    s_and_b32 s65, s65, 7
    s_mul_i32 s88, s65, 28672
    s_add_u32 s65, s78, 1
    s_and_b32 s65, s65, 7
    s_mul_i32 s89, s65, 28672
    s_add_u32 s65, s78, 2
    s_and_b32 s65, s65, 7
    s_mul_i32 s90, s65, 28672
    s_add_u32 s65, s78, 3
    s_and_b32 s65, s65, 7
    s_mul_i32 s91, s65, 28672
    s_add_u32 s65, s78, 4
    s_and_b32 s65, s65, 7
    s_mul_i32 s92, s65, 28672
    s_add_u32 s65, s78, 5
    s_and_b32 s65, s65, 7
    s_mul_i32 s93, s65, 28672
    s_add_u32 s65, s78, 6
    s_and_b32 s65, s65, 7
    s_mul_i32 s94, s65, 28672
    s_add_u32 s65, s78, 7
    s_and_b32 s65, s65, 7
    s_mul_i32 s95, s65, 28672
    v_bfe_u32 v56, v1, 1, 3
    v_xor_b32 v56, v56, v54
    v_xor_b32 v57, 4, v56
    v_min_u32 v56, 6, v56
    v_min_u32 v57, 6, v57
    v_and_b32 v58, 1, v1
    v_lshlrev_b32 v58, 4, v58
    v_mul_u32_u24 v59, 896, v54
    s_mul_i32 s64, s4, 224
    v_add3_u32 v58, v58, v59, s64
    v_lshl_add_u32 v16, v56, 5, v58
    v_lshl_add_u32 v17, v56, 5, v58
    v_add_u32 v17, 2560, v17
    v_lshl_add_u32 v18, v57, 5, v58
    v_add_u32 v18, 5120, v18
    v_lshl_add_u32 v19, v57, 5, v58
    v_add_u32 v19, 7680, v19
    v_and_b32 v56, 31, v1
    v_lshrrev_b32 v57, 5, v1
    v_lshrrev_b32 v58, 3, v56
    v_lshlrev_b32 v58, 10, v58
    v_lshl_add_u32 v58, v53, 7, v58
    v_bfe_u32 v59, v56, 1, 3
    v_xor_b32 v59, v59, v57
    v_xor_b32 v60, 0, v59
    v_lshl_add_u32 v20, v60, 4, v58
    v_add_u32 v24, s5, v20
    v_xor_b32 v60, 2, v59
    v_lshl_add_u32 v21, v60, 4, v58
    v_add_u32 v25, s5, v21
    v_xor_b32 v60, 4, v59
    v_lshl_add_u32 v22, v60, 4, v58
    v_add_u32 v26, s5, v22
    v_xor_b32 v60, 6, v59
    v_lshl_add_u32 v23, v60, 4, v58
    v_add_u32 v27, s5, v23
    v_bfe_u32 v58, v1, 2, 2
    v_and_b32 v59, 3, v1
    v_lshlrev_b32 v60, 7, v58
    v_lshrrev_b32 v61, 1, v58
    v_lshl_add_u32 v60, v61, 6, v60
    v_and_b32 v61, 1, v54
    v_lshl_add_u32 v60, v61, 5, v60
    v_and_b32 v61, 1, v59
    v_lshl_add_u32 v60, v61, 4, v60
    v_lshrrev_b32 v61, 1, v59
    v_lshl_add_u32 v60, v61, 3, v60
    v_add_u32 v60, s5, v60
    v_lshl_add_u32 v28, v57, 10, v60
    v_xor_b32 v29, 64, v28
    v_lshl_add_u32 v30, v57, 9, v60
    v_xor_b32 v31, 64, v30
    v_lshlrev_b32 v60, 11, v54
    v_lshl_add_u32 v60, v58, 8, v60
    v_lshl_add_u32 v60, v59, 3, v60
    v_add_u32 v60, s5, v60
    v_and_b32 v61, 1, v54
    v_lshl_or_b32 v61, v61, 2, v58
    v_lshl_add_u32 v32, v61, 5, v60
    v_xor_b32 v33, 32, v32
    v_xor_b32 v34, 64, v32
    v_xor_b32 v35, 96, v32
    v_xor_b32 v36, 128, v32
    v_xor_b32 v37, 160, v32
    v_xor_b32 v38, 192, v32
    v_lshlrev_b32 v39, 4, v1
    s_lshl_b32 s64, s4, 13
    v_add_u32 v40, s64, v39
    s_lshl_b32 s65, s4, 14
    v_add_u32 v41, s65, v39
    v_lshrrev_b32 v60, 4, v56
    v_lshlrev_b32 v60, 10, v60
    v_lshl_add_u32 v60, v57, 8, v60
    v_and_b32 v61, 15, v1
    v_lshl_add_u32 v60, v61, 4, v60
    s_lshl_b32 s65, s4, 1
    s_add_u32 s65, s65, 8
    s_sub_u32 s65, s65, s78
    s_and_b32 s65, s65, 7
    s_lshl_b32 s65, s65, 12
    v_add_u32 v42, s65, v60
    s_lshl_b32 s65, s4, 1
    s_add_u32 s65, s65, 9
    s_sub_u32 s65, s65, s78
    s_and_b32 s65, s65, 7
    s_lshl_b32 s65, s65, 12
    v_add_u32 v45, s65, v60
    s_lshl_b32 s64, s4, 2
    v_add_u32 v43, s64, v39
    v_lshlrev_b32 v44, 4, v56
    v_lshlrev_b32 v46, 4, v61
    s_mul_i32 s64, s4, 14336
    v_add_u32 v47, s64, v39
    s_waitcnt vmcnt(16)
    s_barrier
    ds_read_b128 a[128:131], v20 offset:0
    ds_read_b128 a[132:135], v20 offset:4096
    ds_read_b128 a[136:139], v21 offset:0
    ds_read_b128 a[140:143], v21 offset:4096
    s_add_u32 m0, s5, 16384
    s_mov_b32 s6, 0
    buffer_load_dwordx4 v8, s[16:19], s6 offen nt lds
    buffer_load_dwordx4 v9, s[16:19], s6 offen offset:1024 nt lds
    buffer_load_dwordx4 v10, s[16:19], s6 offen offset:2048 nt lds
    buffer_load_dwordx4 v11, s[16:19], s6 offen offset:3072 nt lds
    s_add_u32 m0, s5, 20480
    s_add_u32 s6, s82, 0
    buffer_load_dwordx4 v4, s[12:15], s6 offen lds
    buffer_load_dwordx4 v5, s[12:15], s6 offen offset:1024 lds
    buffer_load_dwordx4 v6, s[12:15], s6 offen offset:2048 lds
    buffer_load_dwordx4 v7, s[12:15], s6 offen offset:3072 lds
    s_waitcnt vmcnt(20)
    ds_read_b64_tr_b16 a[0:1], v28 offset:0
    ds_read_b64_tr_b16 a[2:3], v28 offset:512
    ds_read_b64_tr_b16 a[4:5], v29 offset:0
    ds_read_b64_tr_b16 a[6:7], v29 offset:512
    ds_read_b64_tr_b16 a[8:9], v28 offset:2048
    ds_read_b64_tr_b16 a[10:11], v28 offset:2560
    ds_read_b64_tr_b16 a[12:13], v29 offset:2048
    ds_read_b64_tr_b16 a[14:15], v29 offset:2560
    s_waitcnt lgkmcnt(6)
    v_mfma_f32_32x32x16_bf16 v[128:143], a[0:3], a[128:131], 0
    v_mfma_f32_32x32x16_bf16 v[144:159], a[0:3], a[132:135], 0
    ds_read_b128 a[144:147], v22 offset:0
    ds_read_b128 a[148:151], v22 offset:4096
    s_waitcnt lgkmcnt(6)
    v_mfma_f32_32x32x16_bf16 v[160:175], a[4:7], a[128:131], 0
    ds_read_b128 a[152:155], v23 offset:0
    ds_read_b128 a[156:159], v23 offset:4096
    v_mfma_f32_32x32x16_bf16 v[176:191], a[4:7], a[132:135], 0
    s_waitcnt lgkmcnt(4)
    s_add_u32 m0, s5, 0
    s_add_u32 s6, s82, 262144
    buffer_load_dwordx4 v4, s[12:15], s6 offen lds
    v_mfma_f32_32x32x16_bf16 v[128:143], a[8:11], a[136:139], v[128:143]
    v_mfma_f32_32x32x16_bf16 v[144:159], a[8:11], a[140:143], v[144:159]
    buffer_load_dwordx4 v5, s[12:15], s6 offen offset:1024 lds
    s_waitcnt vmcnt(18)
    ds_read_b64_tr_b16 a[16:17], v28 offset:4096
    ds_read_b64_tr_b16 a[18:19], v28 offset:4608
    ds_read_b64_tr_b16 a[20:21], v29 offset:4096
    v_mfma_f32_32x32x16_bf16 v[160:175], a[12:15], a[136:139], v[160:175]
    buffer_load_dwordx4 v6, s[12:15], s6 offen offset:2048 lds
    ds_read_b64_tr_b16 a[22:23], v29 offset:4608
    ds_read_b64_tr_b16 a[24:25], v28 offset:6144
    ds_read_b64_tr_b16 a[26:27], v28 offset:6656
    v_mfma_f32_32x32x16_bf16 v[176:191], a[12:15], a[140:143], v[176:191]
    buffer_load_dwordx4 v7, s[12:15], s6 offen offset:3072 lds
    ds_read_b64_tr_b16 a[28:29], v29 offset:6144
    ds_read_b64_tr_b16 a[30:31], v29 offset:6656
    s_waitcnt lgkmcnt(6)
    v_mfma_f32_32x32x16_bf16 v[128:143], a[16:19], a[144:147], v[128:143]
    v_mfma_f32_32x32x16_bf16 v[144:159], a[16:19], a[148:151], v[144:159]
    ds_read_b128 a[128:131], v20 offset:8192
    ds_read_b128 a[132:135], v20 offset:12288
    s_waitcnt lgkmcnt(6)
    v_mfma_f32_32x32x16_bf16 v[160:175], a[20:23], a[144:147], v[160:175]
    ds_read_b128 a[136:139], v21 offset:8192
    ds_read_b128 a[140:143], v21 offset:12288
    s_waitcnt vmcnt(16)
    ds_read_b64_tr_b16 a[0:1], v28 offset:8192
    ds_read_b64_tr_b16 a[2:3], v28 offset:8704
    v_mfma_f32_32x32x16_bf16 v[176:191], a[20:23], a[148:151], v[176:191]
    s_waitcnt lgkmcnt(6)
    s_add_u32 m0, s5, 4096
    s_add_u32 s6, s83, 0
    buffer_load_dwordx4 v4, s[12:15], s6 offen lds
    ds_read_b64_tr_b16 a[4:5], v29 offset:8192
    v_mfma_f32_32x32x16_bf16 v[128:143], a[24:27], a[152:155], v[128:143]
    ds_read_b64_tr_b16 a[6:7], v29 offset:8704
    ds_read_b64_tr_b16 a[8:9], v28 offset:10240
    ds_read_b64_tr_b16 a[10:11], v28 offset:10752
    ds_read_b64_tr_b16 a[12:13], v29 offset:10240
    v_mfma_f32_32x32x16_bf16 v[144:159], a[24:27], a[156:159], v[144:159]
    buffer_load_dwordx4 v5, s[12:15], s6 offen offset:1024 lds
    ds_read_b64_tr_b16 a[14:15], v29 offset:10752
    v_mfma_f32_32x32x16_bf16 v[160:175], a[28:31], a[152:155], v[160:175]
    buffer_load_dwordx4 v6, s[12:15], s6 offen offset:2048 lds
    v_mfma_f32_32x32x16_bf16 v[176:191], a[28:31], a[156:159], v[176:191]
    buffer_load_dwordx4 v7, s[12:15], s6 offen offset:3072 lds
    s_waitcnt lgkmcnt(6)
    v_mfma_f32_32x32x16_bf16 v[128:143], a[0:3], a[128:131], v[128:143]
    v_mfma_f32_32x32x16_bf16 v[144:159], a[0:3], a[132:135], v[144:159]
    ds_read_b128 a[144:147], v22 offset:8192
    ds_read_b128 a[148:151], v22 offset:12288
    s_waitcnt lgkmcnt(2)
    s_add_u32 m0, s5, 8192
    s_add_u32 s6, s83, 262144
    v_mfma_f32_32x32x16_bf16 v[160:175], a[4:7], a[128:131], v[160:175]
    ds_read_b128 a[152:155], v23 offset:8192
    ds_read_b128 a[156:159], v23 offset:12288
    buffer_load_dwordx4 v4, s[12:15], s6 offen lds
    s_waitcnt vmcnt(17)
    ds_read_b64_tr_b16 a[16:17], v28 offset:12288
    v_mfma_f32_32x32x16_bf16 v[176:191], a[4:7], a[132:135], v[176:191]
    ds_read_b64_tr_b16 a[18:19], v28 offset:12800
    ds_read_b64_tr_b16 a[20:21], v29 offset:12288
    ds_read_b64_tr_b16 a[22:23], v29 offset:12800
    ds_read_b64_tr_b16 a[24:25], v28 offset:14336
    v_mfma_f32_32x32x16_bf16 v[128:143], a[8:11], a[136:139], v[128:143]
    buffer_load_dwordx4 v5, s[12:15], s6 offen offset:1024 lds
    ds_read_b64_tr_b16 a[26:27], v28 offset:14848
    ds_read_b64_tr_b16 a[28:29], v29 offset:14336
    ds_read_b64_tr_b16 a[30:31], v29 offset:14848
    v_mfma_f32_32x32x16_bf16 v[144:159], a[8:11], a[140:143], v[144:159]
    buffer_load_dwordx4 v6, s[12:15], s6 offen offset:2048 lds
    v_mfma_f32_32x32x16_bf16 v[160:175], a[12:15], a[136:139], v[160:175]
    buffer_load_dwordx4 v7, s[12:15], s6 offen offset:3072 lds
    v_mfma_f32_32x32x16_bf16 v[176:191], a[12:15], a[140:143], v[176:191]
    s_waitcnt lgkmcnt(6)
    v_mfma_f32_32x32x16_bf16 v[128:143], a[16:19], a[144:147], v[128:143]
    s_waitcnt lgkmcnt(0)
    s_add_u32 m0, s5, 12288
    s_mov_b32 s6, 128
    buffer_load_dwordx4 v8, s[16:19], s6 offen nt lds
    v_mfma_f32_32x32x16_bf16 v[144:159], a[16:19], a[148:151], v[144:159]
    ds_read_b128 a[128:131], v20 offset:16384
    ds_read_b128 a[132:135], v20 offset:20480
    buffer_load_dwordx4 v9, s[16:19], s6 offen offset:1024 nt lds
    v_mfma_f32_32x32x16_bf16 v[160:175], a[20:23], a[144:147], v[160:175]
    ds_read_b128 a[136:139], v21 offset:16384
    ds_read_b128 a[140:143], v21 offset:20480
    buffer_load_dwordx4 v10, s[16:19], s6 offen offset:2048 nt lds
    v_mfma_f32_32x32x16_bf16 v[176:191], a[20:23], a[148:151], v[176:191]
    v_mfma_f32_32x32x16_bf16 v[128:143], a[24:27], a[152:155], v[128:143]
    buffer_load_dwordx4 v11, s[16:19], s6 offen offset:3072 nt lds
    v_mfma_f32_32x32x16_bf16 v[144:159], a[24:27], a[156:159], v[144:159]
    s_waitcnt vmcnt(20)
    ds_read_b128 v[192:195], v24 offset:16384
    ds_read_b128 v[196:199], v25 offset:16384
    ds_read_b128 v[200:203], v26 offset:16384
    ds_read_b128 v[204:207], v27 offset:16384
    v_mfma_f32_32x32x16_bf16 v[160:175], a[28:31], a[152:155], v[160:175]
    s_waitcnt vmcnt(16)
    ds_read_b64_tr_b16 a[0:1], v28 offset:20480
    ds_read_b64_tr_b16 a[2:3], v28 offset:20992
    ds_read_b64_tr_b16 a[4:5], v29 offset:20480
    ds_read_b64_tr_b16 a[6:7], v29 offset:20992
    v_mfma_f32_32x32x16_bf16 v[176:191], a[28:31], a[156:159], v[176:191]
    s_waitcnt lgkmcnt(4)
    s_add_u32 m0, s5, 16384
    s_add_u32 s6, s84, 0
    buffer_load_dwordx4 v4, s[12:15], s6 offen lds
    ds_read_b64_tr_b16 a[8:9], v28 offset:22528
    ds_read_b64_tr_b16 a[10:11], v28 offset:23040
    ds_read_b64_tr_b16 a[12:13], v29 offset:22528
    ds_read_b64_tr_b16 a[14:15], v29 offset:23040
    s_waitcnt lgkmcnt(6)
    v_mfma_f32_32x32x16_bf16 v[128:143], a[0:3], a[128:131], v[128:143]
    buffer_load_dwordx4 v5, s[12:15], s6 offen offset:1024 lds
    v_mfma_f32_32x32x16_bf16 v[144:159], a[0:3], a[132:135], v[144:159]
    ds_read_b128 a[144:147], v22 offset:16384
    ds_read_b128 a[148:151], v22 offset:20480
    buffer_load_dwordx4 v6, s[12:15], s6 offen offset:2048 lds
    s_waitcnt lgkmcnt(6)
    v_mfma_f32_32x32x16_bf16 v[160:175], a[4:7], a[128:131], v[160:175]
    ds_read_b128 a[152:155], v23 offset:16384
    ds_read_b128 a[156:159], v23 offset:20480
    buffer_load_dwordx4 v7, s[12:15], s6 offen offset:3072 lds
    v_mfma_f32_32x32x16_bf16 v[176:191], a[4:7], a[132:135], v[176:191]
    s_waitcnt lgkmcnt(6)
    v_mfma_f32_32x32x16_bf16 v[128:143], a[8:11], a[136:139], v[128:143]
    s_waitcnt lgkmcnt(4)
    s_add_u32 m0, s5, 20480
    s_add_u32 s6, s84, 262144
    buffer_load_dwordx4 v4, s[12:15], s6 offen lds
    s_waitcnt vmcnt(17)
    ds_read_b64_tr_b16 a[16:17], v28 offset:0
    v_mfma_f32_32x32x16_bf16 v[144:159], a[8:11], a[140:143], v[144:159]
    ds_read_b64_tr_b16 a[18:19], v28 offset:512
    ds_read_b64_tr_b16 a[20:21], v29 offset:0
    ds_read_b64_tr_b16 a[22:23], v29 offset:512
    ds_read_b64_tr_b16 a[24:25], v28 offset:2048
    v_mfma_f32_32x32x16_bf16 v[160:175], a[12:15], a[136:139], v[160:175]
    buffer_load_dwordx4 v5, s[12:15], s6 offen offset:1024 lds
    ds_read_b64_tr_b16 a[26:27], v28 offset:2560
    ds_read_b64_tr_b16 a[28:29], v29 offset:2048
    ds_read_b64_tr_b16 a[30:31], v29 offset:2560
    v_mfma_f32_32x32x16_bf16 v[176:191], a[12:15], a[140:143], v[176:191]
    buffer_load_dwordx4 v6, s[12:15], s6 offen offset:2048 lds
    s_waitcnt lgkmcnt(6)
    v_mfma_f32_32x32x16_bf16 v[128:143], a[16:19], a[144:147], v[128:143]
    buffer_load_dwordx4 v7, s[12:15], s6 offen offset:3072 lds
    v_mfma_f32_32x32x16_bf16 v[144:159], a[16:19], a[148:151], v[144:159]
    ds_read_b128 a[128:131], v20 offset:24576
    ds_read_b128 a[132:135], v20 offset:28672
    s_waitcnt lgkmcnt(6)
    v_mfma_f32_32x32x16_bf16 v[160:175], a[20:23], a[144:147], v[160:175]
    ds_read_b128 a[136:139], v21 offset:24576
    ds_read_b128 a[140:143], v21 offset:28672
    s_waitcnt lgkmcnt(4)
    s_add_u32 m0, s5, 0
    s_add_u32 s6, s85, 0
    v_mfma_f32_32x32x16_bf16 v[176:191], a[20:23], a[148:151], v[176:191]
    buffer_load_dwordx4 v4, s[12:15], s6 offen lds
    s_waitcnt vmcnt(17)
    ds_read_b64_tr_b16 a[0:1], v28 offset:4096
    ds_read_b64_tr_b16 a[2:3], v28 offset:4608
    ds_read_b64_tr_b16 a[4:5], v29 offset:4096
    v_mfma_f32_32x32x16_bf16 v[128:143], a[24:27], a[152:155], v[128:143]
    buffer_load_dwordx4 v5, s[12:15], s6 offen offset:1024 lds
    ds_read_b64_tr_b16 a[6:7], v29 offset:4608
    ds_read_b64_tr_b16 a[8:9], v28 offset:6144
    ds_read_b64_tr_b16 a[10:11], v28 offset:6656
    v_mfma_f32_32x32x16_bf16 v[144:159], a[24:27], a[156:159], v[144:159]
    buffer_load_dwordx4 v6, s[12:15], s6 offen offset:2048 lds
    ds_read_b64_tr_b16 a[12:13], v29 offset:6144
    ds_read_b64_tr_b16 a[14:15], v29 offset:6656
    v_mfma_f32_32x32x16_bf16 v[160:175], a[28:31], a[152:155], v[160:175]
    buffer_load_dwordx4 v7, s[12:15], s6 offen offset:3072 lds
    v_mfma_f32_32x32x16_bf16 v[176:191], a[28:31], a[156:159], v[176:191]
    s_waitcnt lgkmcnt(6)
    v_mfma_f32_32x32x16_bf16 v[128:143], a[0:3], a[128:131], v[128:143]
    s_waitcnt vmcnt(16)
    ds_read_b64_tr_b16 a[16:17], v28 offset:8192
    ds_read_b64_tr_b16 a[18:19], v28 offset:8704
    ds_read_b64_tr_b16 a[20:21], v29 offset:8192
    ds_read_b64_tr_b16 a[22:23], v29 offset:8704
    v_mfma_f32_32x32x16_bf16 v[144:159], a[0:3], a[132:135], v[144:159]
    ds_read_b128 a[144:147], v22 offset:24576
    ds_read_b128 a[148:151], v22 offset:28672
    s_waitcnt lgkmcnt(6)
    s_add_u32 m0, s5, 4096
    s_add_u32 s6, s85, 262144
    v_mfma_f32_32x32x16_bf16 v[160:175], a[4:7], a[128:131], v[160:175]
    ds_read_b128 a[152:155], v23 offset:24576
    ds_read_b128 a[156:159], v23 offset:28672
    buffer_load_dwordx4 v4, s[12:15], s6 offen lds
    ds_read_b64_tr_b16 a[24:25], v28 offset:10240
    v_mfma_f32_32x32x16_bf16 v[176:191], a[4:7], a[132:135], v[176:191]
    ds_read_b64_tr_b16 a[26:27], v28 offset:10752
    ds_read_b64_tr_b16 a[28:29], v29 offset:10240
    ds_read_b64_tr_b16 a[30:31], v29 offset:10752
    v_mfma_f32_32x32x16_bf16 v[128:143], a[8:11], a[136:139], v[128:143]
    buffer_load_dwordx4 v5, s[12:15], s6 offen offset:1024 lds
    v_mfma_f32_32x32x16_bf16 v[144:159], a[8:11], a[140:143], v[144:159]
    buffer_load_dwordx4 v6, s[12:15], s6 offen offset:2048 lds
    v_mfma_f32_32x32x16_bf16 v[160:175], a[12:15], a[136:139], v[160:175]
    buffer_load_dwordx4 v7, s[12:15], s6 offen offset:3072 lds
    v_mfma_f32_32x32x16_bf16 v[176:191], a[12:15], a[140:143], v[176:191]
    s_waitcnt lgkmcnt(0)
    s_add_u32 m0, s5, 8192
    s_mov_b32 s6, 256
    buffer_load_dwordx4 v8, s[16:19], s6 offen nt lds
    v_mfma_f32_32x32x16_bf16 v[128:143], a[16:19], a[144:147], v[128:143]
    v_mfma_f32_32x32x16_bf16 v[144:159], a[16:19], a[148:151], v[144:159]
    ds_read_b128 a[128:131], v20 offset:32768
    ds_read_b128 a[132:135], v20 offset:36864
    buffer_load_dwordx4 v9, s[16:19], s6 offen offset:1024 nt lds
    v_mfma_f32_32x32x16_bf16 v[160:175], a[20:23], a[144:147], v[160:175]
    ds_read_b128 a[136:139], v21 offset:32768
    ds_read_b128 a[140:143], v21 offset:36864
    buffer_load_dwordx4 v10, s[16:19], s6 offen offset:2048 nt lds
    v_mfma_f32_32x32x16_bf16 v[176:191], a[20:23], a[148:151], v[176:191]
    v_mfma_f32_32x32x16_bf16 v[128:143], a[24:27], a[152:155], v[128:143]
    buffer_load_dwordx4 v11, s[16:19], s6 offen offset:3072 nt lds
    v_mfma_f32_32x32x16_bf16 v[144:159], a[24:27], a[156:159], v[144:159]
    s_waitcnt vmcnt(20)
    ds_read_b128 v[208:211], v24 offset:12288
    ds_read_b128 v[212:215], v25 offset:12288
    ds_read_b128 v[216:219], v26 offset:12288
    ds_read_b128 v[220:223], v27 offset:12288
    v_mfma_f32_32x32x16_bf16 v[160:175], a[28:31], a[152:155], v[160:175]
    s_waitcnt vmcnt(16)
    ds_read_b64_tr_b16 a[0:1], v28 offset:16384
    ds_read_b64_tr_b16 a[2:3], v28 offset:16896
    ds_read_b64_tr_b16 a[4:5], v29 offset:16384
    ds_read_b64_tr_b16 a[6:7], v29 offset:16896
    v_mfma_f32_32x32x16_bf16 v[176:191], a[28:31], a[156:159], v[176:191]
    s_waitcnt lgkmcnt(4)
    s_add_u32 m0, s5, 12288
    s_add_u32 s6, s86, 0
    buffer_load_dwordx4 v4, s[12:15], s6 offen lds
    ds_read_b64_tr_b16 a[8:9], v28 offset:18432
    ds_read_b64_tr_b16 a[10:11], v28 offset:18944
    ds_read_b64_tr_b16 a[12:13], v29 offset:18432
    ds_read_b64_tr_b16 a[14:15], v29 offset:18944
    s_waitcnt lgkmcnt(6)
    v_mfma_f32_32x32x16_bf16 v[128:143], a[0:3], a[128:131], v[128:143]
    buffer_load_dwordx4 v5, s[12:15], s6 offen offset:1024 lds
    v_mfma_f32_32x32x16_bf16 v[144:159], a[0:3], a[132:135], v[144:159]
    ds_read_b128 a[144:147], v22 offset:32768
    ds_read_b128 a[148:151], v22 offset:36864
    buffer_load_dwordx4 v6, s[12:15], s6 offen offset:2048 lds
    s_waitcnt lgkmcnt(6)
    v_mfma_f32_32x32x16_bf16 v[160:175], a[4:7], a[128:131], v[160:175]
    ds_read_b128 a[152:155], v23 offset:32768
    ds_read_b128 a[156:159], v23 offset:36864
    buffer_load_dwordx4 v7, s[12:15], s6 offen offset:3072 lds
    v_mfma_f32_32x32x16_bf16 v[176:191], a[4:7], a[132:135], v[176:191]
    s_waitcnt lgkmcnt(6)
    v_mfma_f32_32x32x16_bf16 v[128:143], a[8:11], a[136:139], v[128:143]
    s_waitcnt lgkmcnt(4)
    s_add_u32 m0, s5, 16384
    s_add_u32 s6, s86, 262144
    buffer_load_dwordx4 v4, s[12:15], s6 offen lds
    s_waitcnt vmcnt(17)
    ds_read_b64_tr_b16 a[16:17], v28 offset:20480
    v_mfma_f32_32x32x16_bf16 v[144:159], a[8:11], a[140:143], v[144:159]
    ds_read_b64_tr_b16 a[18:19], v28 offset:20992
    ds_read_b64_tr_b16 a[20:21], v29 offset:20480
    ds_read_b64_tr_b16 a[22:23], v29 offset:20992
    ds_read_b64_tr_b16 a[24:25], v28 offset:22528
    v_mfma_f32_32x32x16_bf16 v[160:175], a[12:15], a[136:139], v[160:175]
    buffer_load_dwordx4 v5, s[12:15], s6 offen offset:1024 lds
    ds_read_b64_tr_b16 a[26:27], v28 offset:23040
    ds_read_b64_tr_b16 a[28:29], v29 offset:22528
    ds_read_b64_tr_b16 a[30:31], v29 offset:23040
    v_mfma_f32_32x32x16_bf16 v[176:191], a[12:15], a[140:143], v[176:191]
    buffer_load_dwordx4 v6, s[12:15], s6 offen offset:2048 lds
    s_waitcnt lgkmcnt(6)
    v_mfma_f32_32x32x16_bf16 v[128:143], a[16:19], a[144:147], v[128:143]
    buffer_load_dwordx4 v7, s[12:15], s6 offen offset:3072 lds
    v_mfma_f32_32x32x16_bf16 v[144:159], a[16:19], a[148:151], v[144:159]
    ds_read_b128 a[128:131], v20 offset:40960
    ds_read_b128 a[132:135], v20 offset:45056
    s_waitcnt lgkmcnt(6)
    v_mfma_f32_32x32x16_bf16 v[160:175], a[20:23], a[144:147], v[160:175]
    ds_read_b128 a[136:139], v21 offset:40960
    ds_read_b128 a[140:143], v21 offset:45056
    s_waitcnt lgkmcnt(4)
    s_add_u32 m0, s5, 20480
    s_mov_b32 s6, 384
    v_mfma_f32_32x32x16_bf16 v[176:191], a[20:23], a[148:151], v[176:191]
    buffer_load_dwordx4 v8, s[16:19], s6 offen nt lds
    s_waitcnt vmcnt(17)
    ds_read_b64_tr_b16 a[0:1], v28 offset:0
    ds_read_b64_tr_b16 a[2:3], v28 offset:512
    ds_read_b64_tr_b16 a[4:5], v29 offset:0
    v_mfma_f32_32x32x16_bf16 v[128:143], a[24:27], a[152:155], v[128:143]
    buffer_load_dwordx4 v9, s[16:19], s6 offen offset:1024 nt lds
    ds_read_b64_tr_b16 a[6:7], v29 offset:512
    ds_read_b64_tr_b16 a[8:9], v28 offset:2048
    ds_read_b64_tr_b16 a[10:11], v28 offset:2560
    v_mfma_f32_32x32x16_bf16 v[144:159], a[24:27], a[156:159], v[144:159]
    buffer_load_dwordx4 v10, s[16:19], s6 offen offset:2048 nt lds
    ds_read_b64_tr_b16 a[12:13], v29 offset:2048
    ds_read_b64_tr_b16 a[14:15], v29 offset:2560
    v_mfma_f32_32x32x16_bf16 v[160:175], a[28:31], a[152:155], v[160:175]
    buffer_load_dwordx4 v11, s[16:19], s6 offen offset:3072 nt lds
    v_mfma_f32_32x32x16_bf16 v[176:191], a[28:31], a[156:159], v[176:191]
    s_waitcnt lgkmcnt(6)
    v_mfma_f32_32x32x16_bf16 v[128:143], a[0:3], a[128:131], v[128:143]
    v_mfma_f32_32x32x16_bf16 v[144:159], a[0:3], a[132:135], v[144:159]
    ds_read_b128 a[144:147], v22 offset:40960
    ds_read_b128 a[148:151], v22 offset:45056
    s_waitcnt lgkmcnt(2)
    s_add_u32 m0, s5, 0
    s_mov_b32 s6, 16384
    v_mfma_f32_32x32x16_bf16 v[160:175], a[4:7], a[128:131], v[160:175]
    ds_read_b128 a[152:155], v23 offset:40960
    ds_read_b128 a[156:159], v23 offset:45056
    buffer_load_dwordx4 v8, s[16:19], s6 offen nt lds
    s_waitcnt vmcnt(17)
    ds_read_b64_tr_b16 a[16:17], v28 offset:4096
    v_mfma_f32_32x32x16_bf16 v[176:191], a[4:7], a[132:135], v[176:191]
    ds_read_b64_tr_b16 a[18:19], v28 offset:4608
    ds_read_b64_tr_b16 a[20:21], v29 offset:4096
    ds_read_b64_tr_b16 a[22:23], v29 offset:4608
    ds_read_b64_tr_b16 a[24:25], v28 offset:6144
    v_mfma_f32_32x32x16_bf16 v[128:143], a[8:11], a[136:139], v[128:143]
    buffer_load_dwordx4 v9, s[16:19], s6 offen offset:1024 nt lds
    ds_read_b64_tr_b16 a[26:27], v28 offset:6656
    ds_read_b64_tr_b16 a[28:29], v29 offset:6144
    ds_read_b64_tr_b16 a[30:31], v29 offset:6656
    v_mfma_f32_32x32x16_bf16 v[144:159], a[8:11], a[140:143], v[144:159]
    buffer_load_dwordx4 v10, s[16:19], s6 offen offset:2048 nt lds
    v_mfma_f32_32x32x16_bf16 v[160:175], a[12:15], a[136:139], v[160:175]
    buffer_load_dwordx4 v11, s[16:19], s6 offen offset:3072 nt lds
    v_mfma_f32_32x32x16_bf16 v[176:191], a[12:15], a[140:143], v[176:191]
    s_waitcnt lgkmcnt(6)
    v_mfma_f32_32x32x16_bf16 v[128:143], a[16:19], a[144:147], v[128:143]
    s_waitcnt lgkmcnt(0)
    s_add_u32 m0, s5, 4096
    s_mov_b32 s6, 16512
    buffer_load_dwordx4 v8, s[16:19], s6 offen nt lds
    v_mfma_f32_32x32x16_bf16 v[144:159], a[16:19], a[148:151], v[144:159]
    ds_read_b128 a[128:131], v20 offset:49152
    ds_read_b128 a[132:135], v20 offset:53248
    buffer_load_dwordx4 v9, s[16:19], s6 offen offset:1024 nt lds
    v_mfma_f32_32x32x16_bf16 v[160:175], a[20:23], a[144:147], v[160:175]
    ds_read_b128 a[136:139], v21 offset:49152
    ds_read_b128 a[140:143], v21 offset:53248
    buffer_load_dwordx4 v10, s[16:19], s6 offen offset:2048 nt lds
    v_mfma_f32_32x32x16_bf16 v[176:191], a[20:23], a[148:151], v[176:191]
    v_mfma_f32_32x32x16_bf16 v[128:143], a[24:27], a[152:155], v[128:143]
    buffer_load_dwordx4 v11, s[16:19], s6 offen offset:3072 nt lds
    v_mfma_f32_32x32x16_bf16 v[144:159], a[24:27], a[156:159], v[144:159]
    s_waitcnt vmcnt(20)
    ds_read_b128 v[224:227], v24 offset:8192
    ds_read_b128 v[228:231], v25 offset:8192
    ds_read_b128 v[232:235], v26 offset:8192
    ds_read_b128 v[236:239], v27 offset:8192
    v_mfma_f32_32x32x16_bf16 v[160:175], a[28:31], a[152:155], v[160:175]
    s_waitcnt vmcnt(16)
    ds_read_b64_tr_b16 a[0:1], v28 offset:12288
    ds_read_b64_tr_b16 a[2:3], v28 offset:12800
    ds_read_b64_tr_b16 a[4:5], v29 offset:12288
    ds_read_b64_tr_b16 a[6:7], v29 offset:12800
    v_mfma_f32_32x32x16_bf16 v[176:191], a[28:31], a[156:159], v[176:191]
    s_waitcnt lgkmcnt(4)
    s_add_u32 m0, s5, 8192
    s_mov_b32 s6, 16640
    buffer_load_dwordx4 v8, s[16:19], s6 offen nt lds
    ds_read_b64_tr_b16 a[8:9], v28 offset:14336
    ds_read_b64_tr_b16 a[10:11], v28 offset:14848
    ds_read_b64_tr_b16 a[12:13], v29 offset:14336
    ds_read_b64_tr_b16 a[14:15], v29 offset:14848
    s_waitcnt lgkmcnt(6)
    v_mfma_f32_32x32x16_bf16 v[128:143], a[0:3], a[128:131], v[128:143]
    buffer_load_dwordx4 v9, s[16:19], s6 offen offset:1024 nt lds
    v_mfma_f32_32x32x16_bf16 v[144:159], a[0:3], a[132:135], v[144:159]
    ds_read_b128 a[144:147], v22 offset:49152
    ds_read_b128 a[148:151], v22 offset:53248
    buffer_load_dwordx4 v10, s[16:19], s6 offen offset:2048 nt lds
    s_waitcnt lgkmcnt(6)
    v_mfma_f32_32x32x16_bf16 v[160:175], a[4:7], a[128:131], v[160:175]
    ds_read_b128 a[152:155], v23 offset:49152
    ds_read_b128 a[156:159], v23 offset:53248
    buffer_load_dwordx4 v11, s[16:19], s6 offen offset:3072 nt lds
    v_mfma_f32_32x32x16_bf16 v[176:191], a[4:7], a[132:135], v[176:191]
    s_waitcnt lgkmcnt(6)
    v_mfma_f32_32x32x16_bf16 v[128:143], a[8:11], a[136:139], v[128:143]
    s_waitcnt lgkmcnt(4)
    s_add_u32 m0, s5, 12288
    s_mov_b32 s6, 16768
    buffer_load_dwordx4 v8, s[16:19], s6 offen nt lds
    s_waitcnt vmcnt(17)
    ds_read_b64_tr_b16 a[16:17], v28 offset:16384
    v_mfma_f32_32x32x16_bf16 v[144:159], a[8:11], a[140:143], v[144:159]
    ds_read_b64_tr_b16 a[18:19], v28 offset:16896
    ds_read_b64_tr_b16 a[20:21], v29 offset:16384
    ds_read_b64_tr_b16 a[22:23], v29 offset:16896
    ds_read_b64_tr_b16 a[24:25], v28 offset:18432
    v_mfma_f32_32x32x16_bf16 v[160:175], a[12:15], a[136:139], v[160:175]
    buffer_load_dwordx4 v9, s[16:19], s6 offen offset:1024 nt lds
    ds_read_b64_tr_b16 a[26:27], v28 offset:18944
    ds_read_b64_tr_b16 a[28:29], v29 offset:18432
    ds_read_b64_tr_b16 a[30:31], v29 offset:18944
    v_mfma_f32_32x32x16_bf16 v[176:191], a[12:15], a[140:143], v[176:191]
    buffer_load_dwordx4 v10, s[16:19], s6 offen offset:2048 nt lds
    s_waitcnt lgkmcnt(6)
    v_mfma_f32_32x32x16_bf16 v[128:143], a[16:19], a[144:147], v[128:143]
    buffer_load_dwordx4 v11, s[16:19], s6 offen offset:3072 nt lds
    v_mfma_f32_32x32x16_bf16 v[144:159], a[16:19], a[148:151], v[144:159]
    s_waitcnt lgkmcnt(4)
    v_mfma_f32_32x32x16_bf16 v[160:175], a[20:23], a[144:147], v[160:175]
    s_waitcnt lgkmcnt(0)
    s_add_u32 m0, s5, 16384
    s_mov_b32 s6, 32768
    buffer_load_dwordx4 v8, s[16:19], s6 offen nt lds
    v_mfma_f32_32x32x16_bf16 v[176:191], a[20:23], a[148:151], v[176:191]
    v_mfma_f32_32x32x16_bf16 v[128:143], a[24:27], a[152:155], v[128:143]
    buffer_load_dwordx4 v9, s[16:19], s6 offen offset:1024 nt lds
    v_mfma_f32_32x32x16_bf16 v[144:159], a[24:27], a[156:159], v[144:159]
    buffer_load_dwordx4 v10, s[16:19], s6 offen offset:2048 nt lds
    v_mfma_f32_32x32x16_bf16 v[160:175], a[28:31], a[152:155], v[160:175]
    buffer_load_dwordx4 v11, s[16:19], s6 offen offset:3072 nt lds
    v_mfma_f32_32x32x16_bf16 v[176:191], a[28:31], a[156:159], v[176:191]
    s_nop 5
    v_cvt_pk_bf16_f32 v128, v128, v129
    v_cvt_pk_bf16_f32 v129, v130, v131
    v_cvt_pk_bf16_f32 v130, v132, v133
    v_cvt_pk_bf16_f32 v131, v134, v135
    v_cvt_pk_bf16_f32 v136, v136, v137
    v_cvt_pk_bf16_f32 v137, v138, v139
    v_cvt_pk_bf16_f32 v138, v140, v141
    v_cvt_pk_bf16_f32 v139, v142, v143
    v_cvt_pk_bf16_f32 v144, v144, v145
    v_cvt_pk_bf16_f32 v145, v146, v147
    v_cvt_pk_bf16_f32 v146, v148, v149
    v_cvt_pk_bf16_f32 v147, v150, v151
    v_cvt_pk_bf16_f32 v152, v152, v153
    v_cvt_pk_bf16_f32 v153, v154, v155
    v_cvt_pk_bf16_f32 v154, v156, v157
    v_cvt_pk_bf16_f32 v155, v158, v159
    v_cvt_pk_bf16_f32 v160, v160, v161
    v_cvt_pk_bf16_f32 v161, v162, v163
    v_cvt_pk_bf16_f32 v162, v164, v165
    v_cvt_pk_bf16_f32 v163, v166, v167
    v_cvt_pk_bf16_f32 v168, v168, v169
    v_cvt_pk_bf16_f32 v169, v170, v171
    v_cvt_pk_bf16_f32 v170, v172, v173
    v_cvt_pk_bf16_f32 v171, v174, v175
    v_cvt_pk_bf16_f32 v176, v176, v177
    v_cvt_pk_bf16_f32 v177, v178, v179
    v_cvt_pk_bf16_f32 v178, v180, v181
    v_cvt_pk_bf16_f32 v179, v182, v183
    v_cvt_pk_bf16_f32 v184, v184, v185
    v_cvt_pk_bf16_f32 v185, v186, v187
    v_cvt_pk_bf16_f32 v186, v188, v189
    v_cvt_pk_bf16_f32 v187, v190, v191
    s_barrier
    ds_write_b128 v40, v[128:131] offset:0
    ds_write_b128 v40, v[136:139] offset:2048
    ds_write_b128 v40, v[144:147] offset:1024
    ds_write_b128 v40, v[152:155] offset:3072
    ds_write_b128 v40, v[160:163] offset:4096
    ds_write_b128 v40, v[168:171] offset:6144
    ds_write_b128 v40, v[176:179] offset:5120
    ds_write_b128 v40, v[184:187] offset:7168
    s_waitcnt lgkmcnt(0)
    s_barrier
    ds_read_b128 a[0:3], v39 offset:0
    ds_read_b128 a[4:7], v39 offset:1024
    ds_read_b128 a[8:11], v39 offset:2048
    ds_read_b128 a[12:15], v39 offset:3072
    ds_read_b128 a[16:19], v39 offset:4096
    ds_read_b128 a[20:23], v39 offset:5120
    ds_read_b128 a[24:27], v39 offset:6144
    ds_read_b128 a[28:31], v39 offset:7168
    s_waitcnt lgkmcnt(7)
    v_mfma_f32_32x32x16_bf16 v[128:143], v[192:195], a[0:3], 0
    s_waitcnt vmcnt(20)
    ds_read_b128 v[240:243], v24 offset:20480
    ds_read_b128 v[244:247], v25 offset:20480
    ds_read_b128 v[248:251], v26 offset:20480
    ds_read_b128 v[252:255], v27 offset:20480
    s_waitcnt lgkmcnt(10)
    v_mfma_f32_32x32x16_bf16 v[144:159], v[192:195], a[4:7], 0
    ds_read_b128 a[32:35], v39 offset:8192
    ds_read_b128 a[36:39], v39 offset:9216
    s_waitcnt lgkmcnt(11)
    v_mfma_f32_32x32x16_bf16 v[128:143], v[196:199], a[8:11], v[128:143]
    ds_read_b128 a[40:43], v39 offset:10240
    ds_read_b128 a[44:47], v39 offset:11264
    s_waitcnt lgkmcnt(12)
    v_mfma_f32_32x32x16_bf16 v[144:159], v[196:199], a[12:15], v[144:159]
    ds_read_b128 a[48:51], v39 offset:12288
    ds_read_b128 a[52:55], v39 offset:13312
    s_waitcnt lgkmcnt(13)
    v_mfma_f32_32x32x16_bf16 v[128:143], v[200:203], a[16:19], v[128:143]
    ds_read_b128 a[56:59], v39 offset:14336
    ds_read_b128 a[60:63], v39 offset:15360
    s_waitcnt lgkmcnt(8)
    s_add_u32 m0, s5, 20480
    s_mov_b32 s6, 32896
    v_mfma_f32_32x32x16_bf16 v[144:159], v[200:203], a[20:23], v[144:159]
    buffer_load_dwordx4 v8, s[16:19], s6 offen nt lds
    v_mfma_f32_32x32x16_bf16 v[128:143], v[204:207], a[24:27], v[128:143]
    buffer_load_dwordx4 v9, s[16:19], s6 offen offset:1024 nt lds
    v_mfma_f32_32x32x16_bf16 v[144:159], v[204:207], a[28:31], v[144:159]
    buffer_load_dwordx4 v10, s[16:19], s6 offen offset:2048 nt lds
    s_waitcnt lgkmcnt(7)
    v_mfma_f32_32x32x16_bf16 v[128:143], v[208:211], a[32:35], v[128:143]
    buffer_load_dwordx4 v11, s[16:19], s6 offen offset:3072 nt lds
    s_waitcnt lgkmcnt(6)
    v_mfma_f32_32x32x16_bf16 v[144:159], v[208:211], a[36:39], v[144:159]
    ds_read_b128 a[64:67], v39 offset:16384
    ds_read_b128 a[68:71], v39 offset:17408
    s_waitcnt lgkmcnt(7)
    v_mfma_f32_32x32x16_bf16 v[128:143], v[212:215], a[40:43], v[128:143]
    ds_read_b128 a[72:75], v39 offset:18432
    ds_read_b128 a[76:79], v39 offset:19456
    s_waitcnt lgkmcnt(8)
    v_mfma_f32_32x32x16_bf16 v[144:159], v[212:215], a[44:47], v[144:159]
    ds_read_b128 a[80:83], v39 offset:20480
    ds_read_b128 a[84:87], v39 offset:21504
    s_waitcnt lgkmcnt(9)
    v_mfma_f32_32x32x16_bf16 v[128:143], v[216:219], a[48:51], v[128:143]
    ds_read_b128 a[88:91], v39 offset:22528
    ds_read_b128 a[92:95], v39 offset:23552
    s_waitcnt lgkmcnt(10)
    v_mfma_f32_32x32x16_bf16 v[144:159], v[216:219], a[52:55], v[144:159]
    s_waitcnt lgkmcnt(9)
    v_mfma_f32_32x32x16_bf16 v[128:143], v[220:223], a[56:59], v[128:143]
    s_waitcnt lgkmcnt(8)
    v_mfma_f32_32x32x16_bf16 v[144:159], v[220:223], a[60:63], v[144:159]
    s_waitcnt vmcnt(20)
    ds_read_b128 v[192:195], v24 offset:0
    ds_read_b128 v[196:199], v25 offset:0
    ds_read_b128 v[200:203], v26 offset:0
    ds_read_b128 v[204:207], v27 offset:0
    s_waitcnt lgkmcnt(11)
    v_mfma_f32_32x32x16_bf16 v[128:143], v[224:227], a[64:67], v[128:143]
    s_waitcnt lgkmcnt(10)
    v_mfma_f32_32x32x16_bf16 v[144:159], v[224:227], a[68:71], v[144:159]
    ds_read_b128 a[96:99], v39 offset:24576
    ds_read_b128 a[100:103], v39 offset:25600
    s_waitcnt lgkmcnt(11)
    v_mfma_f32_32x32x16_bf16 v[128:143], v[228:231], a[72:75], v[128:143]
    ds_read_b128 a[104:107], v39 offset:26624
    ds_read_b128 a[108:111], v39 offset:27648
    s_waitcnt lgkmcnt(12)
    v_mfma_f32_32x32x16_bf16 v[144:159], v[228:231], a[76:79], v[144:159]
    ds_read_b128 a[112:115], v39 offset:28672
    ds_read_b128 a[116:119], v39 offset:29696
    s_waitcnt lgkmcnt(6)
    s_add_u32 m0, s5, 0
    s_mov_b32 s6, 33024
    v_mfma_f32_32x32x16_bf16 v[128:143], v[232:235], a[80:83], v[128:143]
    ds_read_b128 a[120:123], v39 offset:30720
    ds_read_b128 a[124:127], v39 offset:31744
    buffer_load_dwordx4 v8, s[16:19], s6 offen nt lds
    v_mfma_f32_32x32x16_bf16 v[144:159], v[232:235], a[84:87], v[144:159]
    v_mfma_f32_32x32x16_bf16 v[128:143], v[236:239], a[88:91], v[128:143]
    buffer_load_dwordx4 v9, s[16:19], s6 offen offset:1024 nt lds
    v_mfma_f32_32x32x16_bf16 v[144:159], v[236:239], a[92:95], v[144:159]
    buffer_load_dwordx4 v10, s[16:19], s6 offen offset:2048 nt lds
    s_waitcnt lgkmcnt(7)
    v_mfma_f32_32x32x16_bf16 v[128:143], v[240:243], a[96:99], v[128:143]
    buffer_load_dwordx4 v11, s[16:19], s6 offen offset:3072 nt lds
    s_waitcnt lgkmcnt(6)
    v_mfma_f32_32x32x16_bf16 v[144:159], v[240:243], a[100:103], v[144:159]
    s_waitcnt lgkmcnt(5)
    v_mfma_f32_32x32x16_bf16 v[128:143], v[244:247], a[104:107], v[128:143]
    s_waitcnt lgkmcnt(4)
    v_mfma_f32_32x32x16_bf16 v[144:159], v[244:247], a[108:111], v[144:159]
    s_waitcnt lgkmcnt(3)
    v_mfma_f32_32x32x16_bf16 v[128:143], v[248:251], a[112:115], v[128:143]
    s_waitcnt lgkmcnt(2)
    v_mfma_f32_32x32x16_bf16 v[144:159], v[248:251], a[116:119], v[144:159]
    s_waitcnt lgkmcnt(1)
    v_mfma_f32_32x32x16_bf16 v[128:143], v[252:255], a[120:123], v[128:143]
    s_waitcnt lgkmcnt(0)
    v_mfma_f32_32x32x16_bf16 v[144:159], v[252:255], a[124:127], v[144:159]
    v_mfma_f32_32x32x16_bf16 v[160:175], v[192:195], a[0:3], 0
    v_mfma_f32_32x32x16_bf16 v[176:191], v[192:195], a[4:7], 0
    s_waitcnt vmcnt(20)
    ds_read_b128 v[208:211], v24 offset:4096
    ds_read_b128 v[212:215], v25 offset:4096
    ds_read_b128 v[216:219], v26 offset:4096
    ds_read_b128 v[220:223], v27 offset:4096
    v_mfma_f32_32x32x16_bf16 v[160:175], v[196:199], a[8:11], v[160:175]
    s_nop 1
    v_max3_f32 v48, v128, v129, v130
    v_max3_f32 v56, v131, v132, v133
    v_max3_f32 v48, v48, v134, v135
    v_mfma_f32_32x32x16_bf16 v[176:191], v[196:199], a[12:15], v[176:191]
    v_max3_f32 v56, v56, v136, v137
    v_max3_f32 v48, v48, v138, v139
    v_max3_f32 v56, v56, v140, v141
    v_mfma_f32_32x32x16_bf16 v[160:175], v[200:203], a[16:19], v[160:175]
    v_max3_f32 v48, v48, v142, v143
    v_max_f32 v48, v48, v56
    v_mul_f32 v48, s7, v48
    v_mfma_f32_32x32x16_bf16 v[176:191], v[200:203], a[20:23], v[176:191]
    v_max3_f32 v49, v144, v145, v146
    v_max3_f32 v57, v147, v148, v149
    v_max3_f32 v49, v49, v150, v151
    s_waitcnt lgkmcnt(0)
    s_add_u32 m0, s5, 4096
    s_mov_b32 s6, 33152
    v_mfma_f32_32x32x16_bf16 v[160:175], v[204:207], a[24:27], v[160:175]
    v_max3_f32 v57, v57, v152, v153
    v_max3_f32 v49, v49, v154, v155
    v_max3_f32 v57, v57, v156, v157
    buffer_load_dwordx4 v8, s[16:19], s6 offen nt lds
    v_mfma_f32_32x32x16_bf16 v[176:191], v[204:207], a[28:31], v[176:191]
    v_max3_f32 v49, v49, v158, v159
    v_max_f32 v49, v49, v57
    v_mul_f32 v49, s7, v49
    buffer_load_dwordx4 v9, s[16:19], s6 offen offset:1024 nt lds
    v_mfma_f32_32x32x16_bf16 v[160:175], v[208:211], a[32:35], v[160:175]
    v_fma_f32 v128, v128, s7, -v48
    v_fma_f32 v129, v129, s7, -v48
    v_fma_f32 v130, v130, s7, -v48
    buffer_load_dwordx4 v10, s[16:19], s6 offen offset:2048 nt lds
    v_mfma_f32_32x32x16_bf16 v[176:191], v[208:211], a[36:39], v[176:191]
    v_fma_f32 v131, v131, s7, -v48
    v_fma_f32 v132, v132, s7, -v48
    v_fma_f32 v133, v133, s7, -v48
    buffer_load_dwordx4 v11, s[16:19], s6 offen offset:3072 nt lds
    v_mfma_f32_32x32x16_bf16 v[160:175], v[212:215], a[40:43], v[160:175]
    v_fma_f32 v134, v134, s7, -v48
    v_fma_f32 v135, v135, s7, -v48
    v_exp_f32 v128, v128
    v_mfma_f32_32x32x16_bf16 v[176:191], v[212:215], a[44:47], v[176:191]
    v_exp_f32 v129, v129
    v_exp_f32 v130, v130
    v_exp_f32 v131, v131
    v_mfma_f32_32x32x16_bf16 v[160:175], v[216:219], a[48:51], v[160:175]
    v_exp_f32 v132, v132
    v_exp_f32 v133, v133
    v_exp_f32 v134, v134
    v_mfma_f32_32x32x16_bf16 v[176:191], v[216:219], a[52:55], v[176:191]
    v_exp_f32 v135, v135
    v_fma_f32 v136, v136, s7, -v48
    v_fma_f32 v137, v137, s7, -v48
    s_waitcnt vmcnt(20)
    ds_read_b128 v[192:195], v24 offset:8192
    v_mfma_f32_32x32x16_bf16 v[160:175], v[220:223], a[56:59], v[160:175]
    v_fma_f32 v138, v138, s7, -v48
    v_fma_f32 v139, v139, s7, -v48
    v_fma_f32 v140, v140, s7, -v48
    ds_read_b128 v[196:199], v25 offset:8192
    v_mfma_f32_32x32x16_bf16 v[176:191], v[220:223], a[60:63], v[176:191]
    v_fma_f32 v141, v141, s7, -v48
    v_fma_f32 v142, v142, s7, -v48
    v_fma_f32 v143, v143, s7, -v48
    ds_read_b128 v[200:203], v26 offset:8192
    ds_read_b128 v[204:207], v27 offset:8192
    s_waitcnt lgkmcnt(3)
    v_mfma_f32_32x32x16_bf16 v[160:175], v[192:195], a[64:67], v[160:175]
    v_exp_f32 v136, v136
    v_exp_f32 v137, v137
    v_exp_f32 v138, v138
    v_mfma_f32_32x32x16_bf16 v[176:191], v[192:195], a[68:71], v[176:191]
    v_exp_f32 v139, v139
    v_exp_f32 v140, v140
    v_exp_f32 v141, v141
    s_waitcnt lgkmcnt(2)
    v_mfma_f32_32x32x16_bf16 v[160:175], v[196:199], a[72:75], v[160:175]
    v_exp_f32 v142, v142
    v_exp_f32 v143, v143
    v_add_f32 v56, v128, v129
    v_mfma_f32_32x32x16_bf16 v[176:191], v[196:199], a[76:79], v[176:191]
    v_add_f32 v56, v56, v130
    v_add_f32 v56, v56, v131
    v_add_f32 v56, v56, v132
    s_waitcnt lgkmcnt(0)
    s_add_u32 m0, s5, 8192
    s_mov_b32 s6, 49152
    v_mfma_f32_32x32x16_bf16 v[160:175], v[200:203], a[80:83], v[160:175]
    v_add_f32 v56, v56, v133
    v_add_f32 v56, v56, v134
    v_add_f32 v56, v56, v135
    buffer_load_dwordx4 v8, s[16:19], s6 offen nt lds
    v_mfma_f32_32x32x16_bf16 v[176:191], v[200:203], a[84:87], v[176:191]
    v_add_f32 v56, v56, v136
    v_add_f32 v56, v56, v137
    v_add_f32 v56, v56, v138
    buffer_load_dwordx4 v9, s[16:19], s6 offen offset:1024 nt lds
    v_mfma_f32_32x32x16_bf16 v[160:175], v[204:207], a[88:91], v[160:175]
    v_add_f32 v56, v56, v139
    v_add_f32 v56, v56, v140
    v_add_f32 v56, v56, v141
    buffer_load_dwordx4 v10, s[16:19], s6 offen offset:2048 nt lds
    v_mfma_f32_32x32x16_bf16 v[176:191], v[204:207], a[92:95], v[176:191]
    v_add_f32 v56, v56, v142
    v_add_f32 v56, v56, v143
    v_fma_f32 v144, v144, s7, -v49
    buffer_load_dwordx4 v11, s[16:19], s6 offen offset:3072 nt lds
    s_waitcnt vmcnt(20)
    ds_read_b128 v[192:195], v24 offset:12288
    ds_read_b128 v[196:199], v25 offset:12288
    ds_read_b128 v[200:203], v26 offset:12288
    ds_read_b128 v[204:207], v27 offset:12288
    s_waitcnt lgkmcnt(3)
    v_mfma_f32_32x32x16_bf16 v[160:175], v[192:195], a[96:99], v[160:175]
    v_fma_f32 v145, v145, s7, -v49
    v_fma_f32 v146, v146, s7, -v49
    v_fma_f32 v147, v147, s7, -v49
    v_mfma_f32_32x32x16_bf16 v[176:191], v[192:195], a[100:103], v[176:191]
    v_fma_f32 v148, v148, s7, -v49
    v_fma_f32 v149, v149, s7, -v49
    v_fma_f32 v150, v150, s7, -v49
    s_waitcnt lgkmcnt(2)
    v_mfma_f32_32x32x16_bf16 v[160:175], v[196:199], a[104:107], v[160:175]
    v_fma_f32 v151, v151, s7, -v49
    v_exp_f32 v144, v144
    v_exp_f32 v145, v145
    v_mfma_f32_32x32x16_bf16 v[176:191], v[196:199], a[108:111], v[176:191]
    v_exp_f32 v146, v146
    v_exp_f32 v147, v147
    v_exp_f32 v148, v148
    s_waitcnt lgkmcnt(0)
    s_add_u32 m0, s5, 12288
    s_mov_b32 s6, 49280
    v_mfma_f32_32x32x16_bf16 v[160:175], v[200:203], a[112:115], v[160:175]
    v_exp_f32 v149, v149
    v_exp_f32 v150, v150
    v_exp_f32 v151, v151
    buffer_load_dwordx4 v8, s[16:19], s6 offen nt lds
    v_mfma_f32_32x32x16_bf16 v[176:191], v[200:203], a[116:119], v[176:191]
    v_fma_f32 v152, v152, s7, -v49
    v_fma_f32 v153, v153, s7, -v49
    v_fma_f32 v154, v154, s7, -v49
    buffer_load_dwordx4 v9, s[16:19], s6 offen offset:1024 nt lds
    v_mfma_f32_32x32x16_bf16 v[160:175], v[204:207], a[120:123], v[160:175]
    v_fma_f32 v155, v155, s7, -v49
    v_fma_f32 v156, v156, s7, -v49
    v_fma_f32 v157, v157, s7, -v49
    buffer_load_dwordx4 v10, s[16:19], s6 offen offset:2048 nt lds
    v_mfma_f32_32x32x16_bf16 v[176:191], v[204:207], a[124:127], v[176:191]
    v_fma_f32 v158, v158, s7, -v49
    v_fma_f32 v159, v159, s7, -v49
    v_exp_f32 v152, v152
    buffer_load_dwordx4 v11, s[16:19], s6 offen offset:3072 nt lds
    v_exp_f32 v153, v153
    v_exp_f32 v154, v154
    v_exp_f32 v155, v155
    v_exp_f32 v156, v156
    v_exp_f32 v157, v157
    v_exp_f32 v158, v158
    v_exp_f32 v159, v159
    v_add_f32 v57, v144, v145
    v_add_f32 v57, v57, v146
    v_add_f32 v57, v57, v147
    v_add_f32 v57, v57, v148
    v_add_f32 v57, v57, v149
    v_add_f32 v57, v57, v150
    v_add_f32 v57, v57, v151
    v_add_f32 v57, v57, v152
    v_add_f32 v57, v57, v153
    v_add_f32 v57, v57, v154
    v_add_f32 v57, v57, v155
    v_add_f32 v57, v57, v156
    v_add_f32 v57, v57, v157
    v_add_f32 v57, v57, v158
    v_add_f32 v57, v57, v159
    s_waitcnt vmcnt(20)
    ds_read_b128 v[64:67], v24 offset:16384
    ds_read_b128 v[68:71], v25 offset:16384
    ds_read_b128 v[72:75], v26 offset:16384
    ds_read_b128 v[76:79], v27 offset:16384
    s_waitcnt lgkmcnt(3)
    v_mfma_f32_32x32x16_bf16 v[192:207], v[64:67], a[0:3], 0
    v_mfma_f32_32x32x16_bf16 v[208:223], v[64:67], a[4:7], 0
    s_waitcnt lgkmcnt(2)
    v_mfma_f32_32x32x16_bf16 v[192:207], v[68:71], a[8:11], v[192:207]
    v_max3_f32 v50, v160, v161, v162
    v_max3_f32 v58, v163, v164, v165
    v_max3_f32 v50, v50, v166, v167
    v_mfma_f32_32x32x16_bf16 v[208:223], v[68:71], a[12:15], v[208:223]
    v_max3_f32 v58, v58, v168, v169
    v_max3_f32 v50, v50, v170, v171
    v_max3_f32 v58, v58, v172, v173
    s_waitcnt lgkmcnt(0)
    s_add_u32 m0, s5, 16384
    s_mov_b32 s6, 49408
    v_mfma_f32_32x32x16_bf16 v[192:207], v[72:75], a[16:19], v[192:207]
    v_max3_f32 v50, v50, v174, v175
    v_max_f32 v50, v50, v58
    v_mul_f32 v50, s7, v50
    buffer_load_dwordx4 v8, s[16:19], s6 offen nt lds
    v_mfma_f32_32x32x16_bf16 v[208:223], v[72:75], a[20:23], v[208:223]
    v_max3_f32 v51, v176, v177, v178
    v_max3_f32 v59, v179, v180, v181
    v_max3_f32 v51, v51, v182, v183
    buffer_load_dwordx4 v9, s[16:19], s6 offen offset:1024 nt lds
    v_mfma_f32_32x32x16_bf16 v[192:207], v[76:79], a[24:27], v[192:207]
    v_max3_f32 v59, v59, v184, v185
    v_max3_f32 v51, v51, v186, v187
    v_max3_f32 v59, v59, v188, v189
    buffer_load_dwordx4 v10, s[16:19], s6 offen offset:2048 nt lds
    v_mfma_f32_32x32x16_bf16 v[208:223], v[76:79], a[28:31], v[208:223]
    v_max3_f32 v51, v51, v190, v191
    v_max_f32 v51, v51, v59
    v_mul_f32 v51, s7, v51
    buffer_load_dwordx4 v11, s[16:19], s6 offen offset:3072 nt lds
    s_waitcnt vmcnt(20)
    ds_read_b128 v[64:67], v24 offset:20480
    ds_read_b128 v[68:71], v25 offset:20480
    ds_read_b128 v[72:75], v26 offset:20480
    ds_read_b128 v[76:79], v27 offset:20480
    s_waitcnt lgkmcnt(3)
    v_mfma_f32_32x32x16_bf16 v[192:207], v[64:67], a[32:35], v[192:207]
    v_fma_f32 v160, v160, s7, -v50
    v_fma_f32 v161, v161, s7, -v50
    v_fma_f32 v162, v162, s7, -v50
    v_mfma_f32_32x32x16_bf16 v[208:223], v[64:67], a[36:39], v[208:223]
    v_fma_f32 v163, v163, s7, -v50
    v_fma_f32 v164, v164, s7, -v50
    v_fma_f32 v165, v165, s7, -v50
    s_waitcnt lgkmcnt(2)
    v_mfma_f32_32x32x16_bf16 v[192:207], v[68:71], a[40:43], v[192:207]
    v_fma_f32 v166, v166, s7, -v50
    v_fma_f32 v167, v167, s7, -v50
    v_exp_f32 v160, v160
    v_mfma_f32_32x32x16_bf16 v[208:223], v[68:71], a[44:47], v[208:223]
    v_exp_f32 v161, v161
    v_exp_f32 v162, v162
    v_exp_f32 v163, v163
    s_waitcnt lgkmcnt(0)
    s_add_u32 m0, s5, 20480
    s_mov_b32 s6, 49536
    v_mfma_f32_32x32x16_bf16 v[192:207], v[72:75], a[48:51], v[192:207]
    v_exp_f32 v164, v164
    v_exp_f32 v165, v165
    v_exp_f32 v166, v166
    buffer_load_dwordx4 v8, s[16:19], s6 offen nt lds
    v_mfma_f32_32x32x16_bf16 v[208:223], v[72:75], a[52:55], v[208:223]
    v_exp_f32 v167, v167
    v_fma_f32 v168, v168, s7, -v50
    v_fma_f32 v169, v169, s7, -v50
    buffer_load_dwordx4 v9, s[16:19], s6 offen offset:1024 nt lds
    v_mfma_f32_32x32x16_bf16 v[192:207], v[76:79], a[56:59], v[192:207]
    v_fma_f32 v170, v170, s7, -v50
    v_fma_f32 v171, v171, s7, -v50
    v_fma_f32 v172, v172, s7, -v50
    buffer_load_dwordx4 v10, s[16:19], s6 offen offset:2048 nt lds
    v_mfma_f32_32x32x16_bf16 v[208:223], v[76:79], a[60:63], v[208:223]
    v_fma_f32 v173, v173, s7, -v50
    v_fma_f32 v174, v174, s7, -v50
    v_fma_f32 v175, v175, s7, -v50
    buffer_load_dwordx4 v11, s[16:19], s6 offen offset:3072 nt lds
    s_waitcnt vmcnt(20)
    ds_read_b128 v[64:67], v24 offset:0
    ds_read_b128 v[68:71], v25 offset:0
    ds_read_b128 v[72:75], v26 offset:0
    ds_read_b128 v[76:79], v27 offset:0
    s_waitcnt lgkmcnt(3)
    v_mfma_f32_32x32x16_bf16 v[192:207], v[64:67], a[64:67], v[192:207]
    v_exp_f32 v168, v168
    v_exp_f32 v169, v169
    v_exp_f32 v170, v170
    v_mfma_f32_32x32x16_bf16 v[208:223], v[64:67], a[68:71], v[208:223]
    v_exp_f32 v171, v171
    v_exp_f32 v172, v172
    v_exp_f32 v173, v173
    s_waitcnt lgkmcnt(2)
    v_mfma_f32_32x32x16_bf16 v[192:207], v[68:71], a[72:75], v[192:207]
    v_exp_f32 v174, v174
    v_exp_f32 v175, v175
    v_add_f32 v58, v160, v161
    v_mfma_f32_32x32x16_bf16 v[208:223], v[68:71], a[76:79], v[208:223]
    v_add_f32 v58, v58, v162
    v_add_f32 v58, v58, v163
    v_add_f32 v58, v58, v164
    s_waitcnt lgkmcnt(0)
    s_add_u32 m0, s5, 0
    s_mov_b32 s6, 0
    v_mfma_f32_32x32x16_bf16 v[192:207], v[72:75], a[80:83], v[192:207]
    v_add_f32 v58, v58, v165
    v_add_f32 v58, v58, v166
    v_add_f32 v58, v58, v167
    buffer_load_dwordx4 v12, s[20:23], s6 offen nt lds
    v_mfma_f32_32x32x16_bf16 v[208:223], v[72:75], a[84:87], v[208:223]
    v_add_f32 v58, v58, v168
    v_add_f32 v58, v58, v169
    v_add_f32 v58, v58, v170
    buffer_load_dwordx4 v13, s[20:23], s6 offen offset:1024 nt lds
    v_mfma_f32_32x32x16_bf16 v[192:207], v[76:79], a[88:91], v[192:207]
    v_add_f32 v58, v58, v171
    v_add_f32 v58, v58, v172
    v_add_f32 v58, v58, v173
    buffer_load_dwordx4 v14, s[20:23], s6 offen offset:2048 nt lds
    v_mfma_f32_32x32x16_bf16 v[208:223], v[76:79], a[92:95], v[208:223]
    v_add_f32 v58, v58, v174
    v_add_f32 v58, v58, v175
    v_fma_f32 v176, v176, s7, -v51
    buffer_load_dwordx4 v15, s[20:23], s6 offen offset:3072 nt lds
    s_waitcnt vmcnt(20)
    ds_read_b128 v[64:67], v24 offset:4096
    ds_read_b128 v[68:71], v25 offset:4096
    ds_read_b128 v[72:75], v26 offset:4096
    ds_read_b128 v[76:79], v27 offset:4096
    s_waitcnt lgkmcnt(3)
    v_mfma_f32_32x32x16_bf16 v[192:207], v[64:67], a[96:99], v[192:207]
    v_fma_f32 v177, v177, s7, -v51
    v_fma_f32 v178, v178, s7, -v51
    v_fma_f32 v179, v179, s7, -v51
    v_mfma_f32_32x32x16_bf16 v[208:223], v[64:67], a[100:103], v[208:223]
    v_fma_f32 v180, v180, s7, -v51
    v_fma_f32 v181, v181, s7, -v51
    v_fma_f32 v182, v182, s7, -v51
    s_waitcnt lgkmcnt(2)
    v_mfma_f32_32x32x16_bf16 v[192:207], v[68:71], a[104:107], v[192:207]
    v_fma_f32 v183, v183, s7, -v51
    v_exp_f32 v176, v176
    v_exp_f32 v177, v177
    v_mfma_f32_32x32x16_bf16 v[208:223], v[68:71], a[108:111], v[208:223]
    v_exp_f32 v178, v178
    v_exp_f32 v179, v179
    v_exp_f32 v180, v180
    s_waitcnt lgkmcnt(0)
    s_add_u32 m0, s5, 4096
    s_mov_b32 s6, 16384
    v_mfma_f32_32x32x16_bf16 v[192:207], v[72:75], a[112:115], v[192:207]
    v_exp_f32 v181, v181
    v_exp_f32 v182, v182
    v_exp_f32 v183, v183
    buffer_load_dwordx4 v12, s[20:23], s6 offen nt lds
    v_mfma_f32_32x32x16_bf16 v[208:223], v[72:75], a[116:119], v[208:223]
    v_fma_f32 v184, v184, s7, -v51
    v_fma_f32 v185, v185, s7, -v51
    v_fma_f32 v186, v186, s7, -v51
    buffer_load_dwordx4 v13, s[20:23], s6 offen offset:1024 nt lds
    v_mfma_f32_32x32x16_bf16 v[192:207], v[76:79], a[120:123], v[192:207]
    v_fma_f32 v187, v187, s7, -v51
    v_fma_f32 v188, v188, s7, -v51
    v_fma_f32 v189, v189, s7, -v51
    buffer_load_dwordx4 v14, s[20:23], s6 offen offset:2048 nt lds
    v_mfma_f32_32x32x16_bf16 v[208:223], v[76:79], a[124:127], v[208:223]
    v_fma_f32 v190, v190, s7, -v51
    v_fma_f32 v191, v191, s7, -v51
    v_exp_f32 v184, v184
    buffer_load_dwordx4 v15, s[20:23], s6 offen offset:3072 nt lds
    v_exp_f32 v185, v185
    v_exp_f32 v186, v186
    v_exp_f32 v187, v187
    v_exp_f32 v188, v188
    v_exp_f32 v189, v189
    v_exp_f32 v190, v190
    v_exp_f32 v191, v191
    v_add_f32 v59, v176, v177
    v_add_f32 v59, v59, v178
    v_add_f32 v59, v59, v179
    v_add_f32 v59, v59, v180
    v_add_f32 v59, v59, v181
    v_add_f32 v59, v59, v182
    v_add_f32 v59, v59, v183
    v_add_f32 v59, v59, v184
    v_add_f32 v59, v59, v185
    v_add_f32 v59, v59, v186
    v_add_f32 v59, v59, v187
    v_add_f32 v59, v59, v188
    v_add_f32 v59, v59, v189
    v_add_f32 v59, v59, v190
    v_add_f32 v59, v59, v191
    s_waitcnt vmcnt(20)
    ds_read_b128 v[64:67], v24 offset:8192
    ds_read_b128 v[68:71], v25 offset:8192
    ds_read_b128 v[72:75], v26 offset:8192
    ds_read_b128 v[76:79], v27 offset:8192
    s_waitcnt lgkmcnt(3)
    v_mfma_f32_32x32x16_bf16 v[224:239], v[64:67], a[0:3], 0
    v_mfma_f32_32x32x16_bf16 v[240:255], v[64:67], a[4:7], 0
    s_waitcnt lgkmcnt(2)
    v_mfma_f32_32x32x16_bf16 v[224:239], v[68:71], a[8:11], v[224:239]
    v_max3_f32 v52, v192, v193, v194
    v_max3_f32 v60, v195, v196, v197
    v_max3_f32 v52, v52, v198, v199
    v_mfma_f32_32x32x16_bf16 v[240:255], v[68:71], a[12:15], v[240:255]
    v_max3_f32 v60, v60, v200, v201
    v_max3_f32 v52, v52, v202, v203
    v_max3_f32 v60, v60, v204, v205
    s_waitcnt lgkmcnt(0)
    s_add_u32 m0, s5, 8192
    s_mov_b32 s6, 32768
    v_mfma_f32_32x32x16_bf16 v[224:239], v[72:75], a[16:19], v[224:239]
    v_max3_f32 v52, v52, v206, v207
    v_max_f32 v52, v52, v60
    v_mul_f32 v52, s7, v52
    buffer_load_dwordx4 v12, s[20:23], s6 offen nt lds
    v_mfma_f32_32x32x16_bf16 v[240:255], v[72:75], a[20:23], v[240:255]
    v_max3_f32 v53, v208, v209, v210
    v_max3_f32 v61, v211, v212, v213
    v_max3_f32 v53, v53, v214, v215
    buffer_load_dwordx4 v13, s[20:23], s6 offen offset:1024 nt lds
    v_mfma_f32_32x32x16_bf16 v[224:239], v[76:79], a[24:27], v[224:239]
    v_max3_f32 v61, v61, v216, v217
    v_max3_f32 v53, v53, v218, v219
    v_max3_f32 v61, v61, v220, v221
    buffer_load_dwordx4 v14, s[20:23], s6 offen offset:2048 nt lds
    v_mfma_f32_32x32x16_bf16 v[240:255], v[76:79], a[28:31], v[240:255]
    v_max3_f32 v53, v53, v222, v223
    v_max_f32 v53, v53, v61
    v_mul_f32 v53, s7, v53
    buffer_load_dwordx4 v15, s[20:23], s6 offen offset:3072 nt lds
    s_waitcnt vmcnt(20)
    ds_read_b128 v[64:67], v24 offset:12288
    ds_read_b128 v[68:71], v25 offset:12288
    ds_read_b128 v[72:75], v26 offset:12288
    ds_read_b128 v[76:79], v27 offset:12288
    s_waitcnt lgkmcnt(3)
    v_mfma_f32_32x32x16_bf16 v[224:239], v[64:67], a[32:35], v[224:239]
    v_fma_f32 v192, v192, s7, -v52
    v_fma_f32 v193, v193, s7, -v52
    v_fma_f32 v194, v194, s7, -v52
    v_mfma_f32_32x32x16_bf16 v[240:255], v[64:67], a[36:39], v[240:255]
    v_fma_f32 v195, v195, s7, -v52
    v_fma_f32 v196, v196, s7, -v52
    v_fma_f32 v197, v197, s7, -v52
    s_waitcnt lgkmcnt(2)
    v_mfma_f32_32x32x16_bf16 v[224:239], v[68:71], a[40:43], v[224:239]
    v_fma_f32 v198, v198, s7, -v52
    v_fma_f32 v199, v199, s7, -v52
    v_exp_f32 v192, v192
    v_mfma_f32_32x32x16_bf16 v[240:255], v[68:71], a[44:47], v[240:255]
    v_exp_f32 v193, v193
    v_exp_f32 v194, v194
    v_exp_f32 v195, v195
    s_waitcnt lgkmcnt(0)
    s_add_u32 m0, s5, 12288
    s_mov_b32 s6, 49152
    v_mfma_f32_32x32x16_bf16 v[224:239], v[72:75], a[48:51], v[224:239]
    v_exp_f32 v196, v196
    v_exp_f32 v197, v197
    v_exp_f32 v198, v198
    buffer_load_dwordx4 v12, s[20:23], s6 offen nt lds
    v_mfma_f32_32x32x16_bf16 v[240:255], v[72:75], a[52:55], v[240:255]
    v_exp_f32 v199, v199
    v_fma_f32 v200, v200, s7, -v52
    v_fma_f32 v201, v201, s7, -v52
    buffer_load_dwordx4 v13, s[20:23], s6 offen offset:1024 nt lds
    v_mfma_f32_32x32x16_bf16 v[224:239], v[76:79], a[56:59], v[224:239]
    v_fma_f32 v202, v202, s7, -v52
    v_fma_f32 v203, v203, s7, -v52
    v_fma_f32 v204, v204, s7, -v52
    buffer_load_dwordx4 v14, s[20:23], s6 offen offset:2048 nt lds
    v_mfma_f32_32x32x16_bf16 v[240:255], v[76:79], a[60:63], v[240:255]
    v_fma_f32 v205, v205, s7, -v52
    v_fma_f32 v206, v206, s7, -v52
    v_fma_f32 v207, v207, s7, -v52
    buffer_load_dwordx4 v15, s[20:23], s6 offen offset:3072 nt lds
    s_waitcnt vmcnt(20)
    ds_read_b128 v[64:67], v24 offset:16384
    ds_read_b128 v[68:71], v25 offset:16384
    ds_read_b128 v[72:75], v26 offset:16384
    ds_read_b128 v[76:79], v27 offset:16384
    s_waitcnt lgkmcnt(3)
    v_mfma_f32_32x32x16_bf16 v[224:239], v[64:67], a[64:67], v[224:239]
    v_exp_f32 v200, v200
    v_exp_f32 v201, v201
    v_exp_f32 v202, v202
    v_mfma_f32_32x32x16_bf16 v[240:255], v[64:67], a[68:71], v[240:255]
    v_exp_f32 v203, v203
    v_exp_f32 v204, v204
    v_exp_f32 v205, v205
    s_waitcnt lgkmcnt(2)
    v_mfma_f32_32x32x16_bf16 v[224:239], v[68:71], a[72:75], v[224:239]
    v_exp_f32 v206, v206
    v_exp_f32 v207, v207
    v_add_f32 v60, v192, v193
    v_mfma_f32_32x32x16_bf16 v[240:255], v[68:71], a[76:79], v[240:255]
    v_add_f32 v60, v60, v194
    v_add_f32 v60, v60, v195
    v_add_f32 v60, v60, v196
    s_waitcnt lgkmcnt(0)
    s_add_u32 m0, s5, 16384
    s_mov_b32 s6, 65536
    v_mfma_f32_32x32x16_bf16 v[224:239], v[72:75], a[80:83], v[224:239]
    v_add_f32 v60, v60, v197
    v_add_f32 v60, v60, v198
    v_add_f32 v60, v60, v199
    buffer_load_dwordx4 v12, s[20:23], s6 offen nt lds
    v_mfma_f32_32x32x16_bf16 v[240:255], v[72:75], a[84:87], v[240:255]
    v_add_f32 v60, v60, v200
    v_add_f32 v60, v60, v201
    v_add_f32 v60, v60, v202
    buffer_load_dwordx4 v13, s[20:23], s6 offen offset:1024 nt lds
    v_mfma_f32_32x32x16_bf16 v[224:239], v[76:79], a[88:91], v[224:239]
    v_add_f32 v60, v60, v203
    v_add_f32 v60, v60, v204
    v_add_f32 v60, v60, v205
    buffer_load_dwordx4 v14, s[20:23], s6 offen offset:2048 nt lds
    v_mfma_f32_32x32x16_bf16 v[240:255], v[76:79], a[92:95], v[240:255]
    v_add_f32 v60, v60, v206
    v_add_f32 v60, v60, v207
    v_fma_f32 v208, v208, s7, -v53
    buffer_load_dwordx4 v15, s[20:23], s6 offen offset:3072 nt lds
    s_waitcnt vmcnt(20)
    ds_read_b128 v[64:67], v24 offset:20480
    ds_read_b128 v[68:71], v25 offset:20480
    ds_read_b128 v[72:75], v26 offset:20480
    ds_read_b128 v[76:79], v27 offset:20480
    s_waitcnt lgkmcnt(3)
    v_mfma_f32_32x32x16_bf16 v[224:239], v[64:67], a[96:99], v[224:239]
    v_fma_f32 v209, v209, s7, -v53
    v_fma_f32 v210, v210, s7, -v53
    v_fma_f32 v211, v211, s7, -v53
    v_mfma_f32_32x32x16_bf16 v[240:255], v[64:67], a[100:103], v[240:255]
    v_fma_f32 v212, v212, s7, -v53
    v_fma_f32 v213, v213, s7, -v53
    v_fma_f32 v214, v214, s7, -v53
    s_waitcnt lgkmcnt(2)
    v_mfma_f32_32x32x16_bf16 v[224:239], v[68:71], a[104:107], v[224:239]
    v_fma_f32 v215, v215, s7, -v53
    v_exp_f32 v208, v208
    v_exp_f32 v209, v209
    v_mfma_f32_32x32x16_bf16 v[240:255], v[68:71], a[108:111], v[240:255]
    v_exp_f32 v210, v210
    v_exp_f32 v211, v211
    v_exp_f32 v212, v212
    s_waitcnt lgkmcnt(0)
    s_add_u32 m0, s5, 20480
    s_mov_b32 s6, 81920
    v_mfma_f32_32x32x16_bf16 v[224:239], v[72:75], a[112:115], v[224:239]
    v_exp_f32 v213, v213
    v_exp_f32 v214, v214
    v_exp_f32 v215, v215
    buffer_load_dwordx4 v12, s[20:23], s6 offen nt lds
    v_mfma_f32_32x32x16_bf16 v[240:255], v[72:75], a[116:119], v[240:255]
    v_fma_f32 v216, v216, s7, -v53
    v_fma_f32 v217, v217, s7, -v53
    v_fma_f32 v218, v218, s7, -v53
    buffer_load_dwordx4 v13, s[20:23], s6 offen offset:1024 nt lds
    v_mfma_f32_32x32x16_bf16 v[224:239], v[76:79], a[120:123], v[224:239]
    v_fma_f32 v219, v219, s7, -v53
    v_fma_f32 v220, v220, s7, -v53
    v_fma_f32 v221, v221, s7, -v53
    buffer_load_dwordx4 v14, s[20:23], s6 offen offset:2048 nt lds
    v_mfma_f32_32x32x16_bf16 v[240:255], v[76:79], a[124:127], v[240:255]
    v_fma_f32 v222, v222, s7, -v53
    v_fma_f32 v223, v223, s7, -v53
    v_exp_f32 v216, v216
    buffer_load_dwordx4 v15, s[20:23], s6 offen offset:3072 nt lds
    v_exp_f32 v217, v217
    v_exp_f32 v218, v218
    v_exp_f32 v219, v219
    v_exp_f32 v220, v220
    v_exp_f32 v221, v221
    v_exp_f32 v222, v222
    v_exp_f32 v223, v223
    v_add_f32 v61, v208, v209
    v_add_f32 v61, v61, v210
    v_add_f32 v61, v61, v211
    v_add_f32 v61, v61, v212
    v_add_f32 v61, v61, v213
    v_add_f32 v61, v61, v214
    v_add_f32 v61, v61, v215
    v_add_f32 v61, v61, v216
    v_add_f32 v61, v61, v217
    v_add_f32 v61, v61, v218
    v_add_f32 v61, v61, v219
    v_add_f32 v61, v61, v220
    v_add_f32 v61, v61, v221
    v_add_f32 v61, v61, v222
    v_add_f32 v61, v61, v223
    v_max3_f32 v54, v224, v225, v226
    v_max3_f32 v62, v227, v228, v229
    v_max3_f32 v54, v54, v230, v231
    v_max3_f32 v62, v62, v232, v233
    v_max3_f32 v54, v54, v234, v235
    v_max3_f32 v62, v62, v236, v237
    v_max3_f32 v54, v54, v238, v239
    v_max_f32 v54, v54, v62
    v_mul_f32 v54, s7, v54
    v_max3_f32 v55, v240, v241, v242
    v_max3_f32 v63, v243, v244, v245
    v_max3_f32 v55, v55, v246, v247
    v_max3_f32 v63, v63, v248, v249
    v_max3_f32 v55, v55, v250, v251
    v_max3_f32 v63, v63, v252, v253
    v_max3_f32 v55, v55, v254, v255
    v_max_f32 v55, v55, v63
    v_mul_f32 v55, s7, v55
    v_max3_f32 v20, v48, v50, v52
    v_max_f32 v20, v20, v54
    v_max3_f32 v21, v49, v51, v53
    v_max_f32 v21, v21, v55
    s_nop 1
    v_permlane32_swap_b32 v20, v21
    v_max_f32 v20, v20, v21
    ds_write_b32 v43, v20 offset:57344
    v_fma_f32 v224, v224, s7, -v54
    v_fma_f32 v225, v225, s7, -v54
    v_fma_f32 v226, v226, s7, -v54
    v_fma_f32 v227, v227, s7, -v54
    v_fma_f32 v228, v228, s7, -v54
    v_fma_f32 v229, v229, s7, -v54
    v_fma_f32 v230, v230, s7, -v54
    v_fma_f32 v231, v231, s7, -v54
    v_exp_f32 v224, v224
    v_exp_f32 v225, v225
    v_exp_f32 v226, v226
    v_exp_f32 v227, v227
    s_waitcnt vmcnt(20)
    ds_read_b64_tr_b16 v[64:65], v30 offset:0
    ds_read_b64_tr_b16 v[66:67], v30 offset:1024
    ds_read_b64_tr_b16 v[68:69], v31 offset:0
    v_exp_f32 v228, v228
    v_exp_f32 v229, v229
    v_exp_f32 v230, v230
    v_exp_f32 v231, v231
    ds_read_b64_tr_b16 v[70:71], v31 offset:1024
    ds_read_b64_tr_b16 v[72:73], v30 offset:2048
    ds_read_b64_tr_b16 v[74:75], v30 offset:3072
    v_fma_f32 v232, v232, s7, -v54
    v_fma_f32 v233, v233, s7, -v54
    v_fma_f32 v234, v234, s7, -v54
    v_fma_f32 v235, v235, s7, -v54
    ds_read_b64_tr_b16 v[76:77], v31 offset:2048
    ds_read_b64_tr_b16 v[78:79], v31 offset:3072
    v_fma_f32 v236, v236, s7, -v54
    v_fma_f32 v237, v237, s7, -v54
    v_fma_f32 v238, v238, s7, -v54
    v_fma_f32 v239, v239, s7, -v54
    v_exp_f32 v232, v232
    v_exp_f32 v233, v233
    v_exp_f32 v234, v234
    v_exp_f32 v235, v235
    v_exp_f32 v236, v236
    v_exp_f32 v237, v237
    v_exp_f32 v238, v238
    v_exp_f32 v239, v239
    v_add_f32 v62, v224, v225
    v_add_f32 v62, v62, v226
    v_add_f32 v62, v62, v227
    v_add_f32 v62, v62, v228
    v_add_f32 v62, v62, v229
    v_add_f32 v62, v62, v230
    v_add_f32 v62, v62, v231
    v_add_f32 v62, v62, v232
    s_waitcnt lgkmcnt(0)
    s_add_u32 m0, s5, 0
    s_mov_b32 s6, 98304
    buffer_load_dwordx4 v12, s[20:23], s6 offen nt lds
    v_add_f32 v62, v62, v233
    v_add_f32 v62, v62, v234
    v_add_f32 v62, v62, v235
    v_add_f32 v62, v62, v236
    v_add_f32 v62, v62, v237
    v_add_f32 v62, v62, v238
    v_add_f32 v62, v62, v239
    s_barrier
    ds_read_b128 v[4:7], v44 offset:57344
    ds_read_b128 v[8:11], v44 offset:57856
    v_fma_f32 v240, v240, s7, -v55
    buffer_load_dwordx4 v13, s[20:23], s6 offen offset:1024 nt lds
    v_fma_f32 v241, v241, s7, -v55
    v_fma_f32 v242, v242, s7, -v55
    v_fma_f32 v243, v243, s7, -v55
    v_fma_f32 v244, v244, s7, -v55
    v_fma_f32 v245, v245, s7, -v55
    v_fma_f32 v246, v246, s7, -v55
    v_fma_f32 v247, v247, s7, -v55
    v_exp_f32 v240, v240
    buffer_load_dwordx4 v14, s[20:23], s6 offen offset:2048 nt lds
    v_exp_f32 v241, v241
    v_exp_f32 v242, v242
    v_exp_f32 v243, v243
    v_exp_f32 v244, v244
    buffer_load_dwordx4 v15, s[20:23], s6 offen offset:3072 nt lds
    v_exp_f32 v245, v245
    v_exp_f32 v246, v246
    v_exp_f32 v247, v247
    v_fma_f32 v248, v248, s7, -v55
    v_fma_f32 v249, v249, s7, -v55
    v_fma_f32 v250, v250, s7, -v55
    v_fma_f32 v251, v251, s7, -v55
    v_fma_f32 v252, v252, s7, -v55
    v_fma_f32 v253, v253, s7, -v55
    v_fma_f32 v254, v254, s7, -v55
    v_fma_f32 v255, v255, s7, -v55
    v_exp_f32 v248, v248
    v_exp_f32 v249, v249
    v_exp_f32 v250, v250
    v_exp_f32 v251, v251
    v_exp_f32 v252, v252
    v_exp_f32 v253, v253
    v_exp_f32 v254, v254
    v_exp_f32 v255, v255
    v_add_f32 v63, v240, v241
    v_add_f32 v63, v63, v242
    v_add_f32 v63, v63, v243
    v_add_f32 v63, v63, v244
    v_add_f32 v63, v63, v245
    s_waitcnt vmcnt(20)
    ds_read_b64_tr_b16 v[80:81], v30 offset:4096
    ds_read_b64_tr_b16 v[82:83], v30 offset:5120
    ds_read_b64_tr_b16 v[84:85], v31 offset:4096
    v_add_f32 v63, v63, v246
    v_add_f32 v63, v63, v247
    v_add_f32 v63, v63, v248
    v_add_f32 v63, v63, v249
    ds_read_b64_tr_b16 v[86:87], v31 offset:5120
    ds_read_b64_tr_b16 v[88:89], v30 offset:6144
    ds_read_b64_tr_b16 v[90:91], v30 offset:7168
    v_add_f32 v63, v63, v250
    v_add_f32 v63, v63, v251
    v_add_f32 v63, v63, v252
    v_add_f32 v63, v63, v253
    ds_read_b64_tr_b16 v[92:93], v31 offset:6144
    ds_read_b64_tr_b16 v[94:95], v31 offset:7168
    v_add_f32 v63, v63, v254
    v_add_f32 v63, v63, v255
    s_waitcnt lgkmcnt(9)
    v_max3_f32 v20, v4, v5, v6
    v_max_f32 v20, v20, v7
    s_waitcnt lgkmcnt(8)
    v_max3_f32 v21, v8, v9, v10
    v_max_f32 v21, v21, v11
    s_waitcnt lgkmcnt(0)
    s_barrier
    v_sub_f32 v48, v48, v20
    v_sub_f32 v49, v49, v21
    v_sub_f32 v50, v50, v20
    v_sub_f32 v51, v51, v21
    v_sub_f32 v52, v52, v20
    v_sub_f32 v53, v53, v21
    v_sub_f32 v54, v54, v20
    v_sub_f32 v55, v55, v21
    v_exp_f32 v48, v48
    v_exp_f32 v49, v49
    v_exp_f32 v50, v50
    v_exp_f32 v51, v51
    v_exp_f32 v52, v52
    v_exp_f32 v53, v53
    v_exp_f32 v54, v54
    v_exp_f32 v55, v55
    v_mul_f32 v22, v56, v48
    v_fmac_f32 v22, v58, v50
    v_fmac_f32 v22, v60, v52
    v_fmac_f32 v22, v62, v54
    v_mul_f32 v23, v57, v49
    v_fmac_f32 v23, v59, v51
    v_fmac_f32 v23, v61, v53
    v_fmac_f32 v23, v63, v55
    s_nop 1
    v_permlane32_swap_b32 v22, v23
    v_add_f32 v22, v22, v23
    v_pk_mul_f32 v[128:129], v[128:129], v[48:49] op_sel:[0,0] op_sel_hi:[1,0]
    v_pk_mul_f32 v[130:131], v[130:131], v[48:49] op_sel:[0,0] op_sel_hi:[1,0]
    s_add_u32 m0, s5, 4096
    s_mov_b32 s6, 114688
    buffer_load_dwordx4 v12, s[20:23], s6 offen nt lds
    v_pk_mul_f32 v[132:133], v[132:133], v[48:49] op_sel:[0,0] op_sel_hi:[1,0]
    v_pk_mul_f32 v[134:135], v[134:135], v[48:49] op_sel:[0,0] op_sel_hi:[1,0]
    v_cvt_pk_bf16_f32 v128, v128, v129
    v_cvt_pk_bf16_f32 v129, v130, v131
    v_cvt_pk_bf16_f32 v130, v132, v133
    v_cvt_pk_bf16_f32 v131, v134, v135
    ds_write_b128 v41, v[128:131] offset:0
    v_pk_mul_f32 v[136:137], v[136:137], v[48:49] op_sel:[0,0] op_sel_hi:[1,0]
    v_pk_mul_f32 v[138:139], v[138:139], v[48:49] op_sel:[0,0] op_sel_hi:[1,0]
    buffer_load_dwordx4 v13, s[20:23], s6 offen offset:1024 nt lds
    v_pk_mul_f32 v[140:141], v[140:141], v[48:49] op_sel:[0,0] op_sel_hi:[1,0]
    v_pk_mul_f32 v[142:143], v[142:143], v[48:49] op_sel:[0,0] op_sel_hi:[1,0]
    v_cvt_pk_bf16_f32 v136, v136, v137
    v_cvt_pk_bf16_f32 v137, v138, v139
    v_cvt_pk_bf16_f32 v138, v140, v141
    v_cvt_pk_bf16_f32 v139, v142, v143
    ds_write_b128 v41, v[136:139] offset:2048
    v_pk_mul_f32 v[144:145], v[144:145], v[48:49] op_sel:[0,1] op_sel_hi:[1,1]
    v_pk_mul_f32 v[146:147], v[146:147], v[48:49] op_sel:[0,1] op_sel_hi:[1,1]
    buffer_load_dwordx4 v14, s[20:23], s6 offen offset:2048 nt lds
    v_pk_mul_f32 v[148:149], v[148:149], v[48:49] op_sel:[0,1] op_sel_hi:[1,1]
    v_pk_mul_f32 v[150:151], v[150:151], v[48:49] op_sel:[0,1] op_sel_hi:[1,1]
    v_cvt_pk_bf16_f32 v144, v144, v145
    v_cvt_pk_bf16_f32 v145, v146, v147
    v_cvt_pk_bf16_f32 v146, v148, v149
    v_cvt_pk_bf16_f32 v147, v150, v151
    ds_write_b128 v41, v[144:147] offset:1024
    v_pk_mul_f32 v[152:153], v[152:153], v[48:49] op_sel:[0,1] op_sel_hi:[1,1]
    v_pk_mul_f32 v[154:155], v[154:155], v[48:49] op_sel:[0,1] op_sel_hi:[1,1]
    buffer_load_dwordx4 v15, s[20:23], s6 offen offset:3072 nt lds
    v_pk_mul_f32 v[156:157], v[156:157], v[48:49] op_sel:[0,1] op_sel_hi:[1,1]
    v_pk_mul_f32 v[158:159], v[158:159], v[48:49] op_sel:[0,1] op_sel_hi:[1,1]
    v_cvt_pk_bf16_f32 v152, v152, v153
    v_cvt_pk_bf16_f32 v153, v154, v155
    v_cvt_pk_bf16_f32 v154, v156, v157
    v_cvt_pk_bf16_f32 v155, v158, v159
    ds_write_b128 v41, v[152:155] offset:3072
    v_pk_mul_f32 v[160:161], v[160:161], v[50:51] op_sel:[0,0] op_sel_hi:[1,0]
    v_pk_mul_f32 v[162:163], v[162:163], v[50:51] op_sel:[0,0] op_sel_hi:[1,0]
    v_pk_mul_f32 v[164:165], v[164:165], v[50:51] op_sel:[0,0] op_sel_hi:[1,0]
    v_pk_mul_f32 v[166:167], v[166:167], v[50:51] op_sel:[0,0] op_sel_hi:[1,0]
    v_cvt_pk_bf16_f32 v160, v160, v161
    v_cvt_pk_bf16_f32 v161, v162, v163
    s_waitcnt vmcnt(20)
    ds_read_b64_tr_b16 v[96:97], v30 offset:8192
    ds_read_b64_tr_b16 v[98:99], v30 offset:9216
    ds_read_b64_tr_b16 v[100:101], v31 offset:8192
    v_cvt_pk_bf16_f32 v162, v164, v165
    v_cvt_pk_bf16_f32 v163, v166, v167
    ds_write_b128 v41, v[160:163] offset:4096
    v_pk_mul_f32 v[168:169], v[168:169], v[50:51] op_sel:[0,0] op_sel_hi:[1,0]
    v_pk_mul_f32 v[170:171], v[170:171], v[50:51] op_sel:[0,0] op_sel_hi:[1,0]
    ds_read_b64_tr_b16 v[102:103], v31 offset:9216
    ds_read_b64_tr_b16 v[104:105], v30 offset:10240
    ds_read_b64_tr_b16 v[106:107], v30 offset:11264
    v_pk_mul_f32 v[172:173], v[172:173], v[50:51] op_sel:[0,0] op_sel_hi:[1,0]
    v_pk_mul_f32 v[174:175], v[174:175], v[50:51] op_sel:[0,0] op_sel_hi:[1,0]
    v_cvt_pk_bf16_f32 v168, v168, v169
    v_cvt_pk_bf16_f32 v169, v170, v171
    ds_read_b64_tr_b16 v[108:109], v31 offset:10240
    ds_read_b64_tr_b16 v[110:111], v31 offset:11264
    v_cvt_pk_bf16_f32 v170, v172, v173
    v_cvt_pk_bf16_f32 v171, v174, v175
    ds_write_b128 v41, v[168:171] offset:6144
    v_pk_mul_f32 v[176:177], v[176:177], v[50:51] op_sel:[0,1] op_sel_hi:[1,1]
    v_pk_mul_f32 v[178:179], v[178:179], v[50:51] op_sel:[0,1] op_sel_hi:[1,1]
    v_pk_mul_f32 v[180:181], v[180:181], v[50:51] op_sel:[0,1] op_sel_hi:[1,1]
    v_pk_mul_f32 v[182:183], v[182:183], v[50:51] op_sel:[0,1] op_sel_hi:[1,1]
    v_cvt_pk_bf16_f32 v176, v176, v177
    v_cvt_pk_bf16_f32 v177, v178, v179
    v_cvt_pk_bf16_f32 v178, v180, v181
    v_cvt_pk_bf16_f32 v179, v182, v183
    ds_write_b128 v41, v[176:179] offset:5120
    v_pk_mul_f32 v[184:185], v[184:185], v[50:51] op_sel:[0,1] op_sel_hi:[1,1]
    v_pk_mul_f32 v[186:187], v[186:187], v[50:51] op_sel:[0,1] op_sel_hi:[1,1]
    v_pk_mul_f32 v[188:189], v[188:189], v[50:51] op_sel:[0,1] op_sel_hi:[1,1]
    v_pk_mul_f32 v[190:191], v[190:191], v[50:51] op_sel:[0,1] op_sel_hi:[1,1]
    v_cvt_pk_bf16_f32 v184, v184, v185
    v_cvt_pk_bf16_f32 v185, v186, v187
    v_cvt_pk_bf16_f32 v186, v188, v189
    v_cvt_pk_bf16_f32 v187, v190, v191
    s_waitcnt lgkmcnt(14)
    ds_write_b128 v41, v[184:187] offset:7168
    v_pk_mul_f32 v[192:193], v[192:193], v[52:53] op_sel:[0,0] op_sel_hi:[1,0]
    v_pk_mul_f32 v[194:195], v[194:195], v[52:53] op_sel:[0,0] op_sel_hi:[1,0]
    s_waitcnt lgkmcnt(3)
    s_add_u32 m0, s5, 8192
    s_mov_b32 s6, 131072
    buffer_load_dwordx4 v12, s[20:23], s6 offen nt lds
    v_pk_mul_f32 v[196:197], v[196:197], v[52:53] op_sel:[0,0] op_sel_hi:[1,0]
    v_pk_mul_f32 v[198:199], v[198:199], v[52:53] op_sel:[0,0] op_sel_hi:[1,0]
    v_cvt_pk_bf16_f32 v192, v192, v193
    v_cvt_pk_bf16_f32 v193, v194, v195
    v_cvt_pk_bf16_f32 v194, v196, v197
    v_cvt_pk_bf16_f32 v195, v198, v199
    ds_write_b128 v41, v[192:195] offset:8192
    v_pk_mul_f32 v[200:201], v[200:201], v[52:53] op_sel:[0,0] op_sel_hi:[1,0]
    v_pk_mul_f32 v[202:203], v[202:203], v[52:53] op_sel:[0,0] op_sel_hi:[1,0]
    buffer_load_dwordx4 v13, s[20:23], s6 offen offset:1024 nt lds
    v_pk_mul_f32 v[204:205], v[204:205], v[52:53] op_sel:[0,0] op_sel_hi:[1,0]
    v_pk_mul_f32 v[206:207], v[206:207], v[52:53] op_sel:[0,0] op_sel_hi:[1,0]
    v_cvt_pk_bf16_f32 v200, v200, v201
    v_cvt_pk_bf16_f32 v201, v202, v203
    v_cvt_pk_bf16_f32 v202, v204, v205
    v_cvt_pk_bf16_f32 v203, v206, v207
    ds_write_b128 v41, v[200:203] offset:10240
    v_pk_mul_f32 v[208:209], v[208:209], v[52:53] op_sel:[0,1] op_sel_hi:[1,1]
    v_pk_mul_f32 v[210:211], v[210:211], v[52:53] op_sel:[0,1] op_sel_hi:[1,1]
    buffer_load_dwordx4 v14, s[20:23], s6 offen offset:2048 nt lds
    v_pk_mul_f32 v[212:213], v[212:213], v[52:53] op_sel:[0,1] op_sel_hi:[1,1]
    v_pk_mul_f32 v[214:215], v[214:215], v[52:53] op_sel:[0,1] op_sel_hi:[1,1]
    v_cvt_pk_bf16_f32 v208, v208, v209
    v_cvt_pk_bf16_f32 v209, v210, v211
    v_cvt_pk_bf16_f32 v210, v212, v213
    v_cvt_pk_bf16_f32 v211, v214, v215
    ds_write_b128 v41, v[208:211] offset:9216
    v_pk_mul_f32 v[216:217], v[216:217], v[52:53] op_sel:[0,1] op_sel_hi:[1,1]
    v_pk_mul_f32 v[218:219], v[218:219], v[52:53] op_sel:[0,1] op_sel_hi:[1,1]
    buffer_load_dwordx4 v15, s[20:23], s6 offen offset:3072 nt lds
    v_pk_mul_f32 v[220:221], v[220:221], v[52:53] op_sel:[0,1] op_sel_hi:[1,1]
    v_pk_mul_f32 v[222:223], v[222:223], v[52:53] op_sel:[0,1] op_sel_hi:[1,1]
    v_cvt_pk_bf16_f32 v216, v216, v217
    v_cvt_pk_bf16_f32 v217, v218, v219
    v_cvt_pk_bf16_f32 v218, v220, v221
    v_cvt_pk_bf16_f32 v219, v222, v223
    ds_write_b128 v41, v[216:219] offset:11264
    v_pk_mul_f32 v[224:225], v[224:225], v[54:55] op_sel:[0,0] op_sel_hi:[1,0]
    v_pk_mul_f32 v[226:227], v[226:227], v[54:55] op_sel:[0,0] op_sel_hi:[1,0]
    v_pk_mul_f32 v[228:229], v[228:229], v[54:55] op_sel:[0,0] op_sel_hi:[1,0]
    v_pk_mul_f32 v[230:231], v[230:231], v[54:55] op_sel:[0,0] op_sel_hi:[1,0]
    v_cvt_pk_bf16_f32 v224, v224, v225
    v_cvt_pk_bf16_f32 v225, v226, v227
    v_cvt_pk_bf16_f32 v226, v228, v229
    v_cvt_pk_bf16_f32 v227, v230, v231
    ds_write_b128 v41, v[224:227] offset:12288
    v_pk_mul_f32 v[232:233], v[232:233], v[54:55] op_sel:[0,0] op_sel_hi:[1,0]
    v_pk_mul_f32 v[234:235], v[234:235], v[54:55] op_sel:[0,0] op_sel_hi:[1,0]
    v_pk_mul_f32 v[236:237], v[236:237], v[54:55] op_sel:[0,0] op_sel_hi:[1,0]
    v_pk_mul_f32 v[238:239], v[238:239], v[54:55] op_sel:[0,0] op_sel_hi:[1,0]
    v_cvt_pk_bf16_f32 v232, v232, v233
    v_cvt_pk_bf16_f32 v233, v234, v235
    v_cvt_pk_bf16_f32 v234, v236, v237
    v_cvt_pk_bf16_f32 v235, v238, v239
    ds_write_b128 v41, v[232:235] offset:14336
    v_pk_mul_f32 v[240:241], v[240:241], v[54:55] op_sel:[0,1] op_sel_hi:[1,1]
    v_pk_mul_f32 v[242:243], v[242:243], v[54:55] op_sel:[0,1] op_sel_hi:[1,1]
    v_pk_mul_f32 v[244:245], v[244:245], v[54:55] op_sel:[0,1] op_sel_hi:[1,1]
    v_pk_mul_f32 v[246:247], v[246:247], v[54:55] op_sel:[0,1] op_sel_hi:[1,1]
    v_cvt_pk_bf16_f32 v240, v240, v241
    v_cvt_pk_bf16_f32 v241, v242, v243
    s_waitcnt vmcnt(20)
    ds_read_b64_tr_b16 v[112:113], v30 offset:12288
    ds_read_b64_tr_b16 v[114:115], v30 offset:13312
    ds_read_b64_tr_b16 v[116:117], v31 offset:12288
    v_cvt_pk_bf16_f32 v242, v244, v245
    v_cvt_pk_bf16_f32 v243, v246, v247
    ds_write_b128 v41, v[240:243] offset:13312
    v_pk_mul_f32 v[248:249], v[248:249], v[54:55] op_sel:[0,1] op_sel_hi:[1,1]
    v_pk_mul_f32 v[250:251], v[250:251], v[54:55] op_sel:[0,1] op_sel_hi:[1,1]
    ds_read_b64_tr_b16 v[118:119], v31 offset:13312
    ds_read_b64_tr_b16 v[120:121], v30 offset:14336
    s_waitcnt lgkmcnt(14)
    ds_read_b64_tr_b16 v[122:123], v30 offset:15360
    v_pk_mul_f32 v[252:253], v[252:253], v[54:55] op_sel:[0,1] op_sel_hi:[1,1]
    v_pk_mul_f32 v[254:255], v[254:255], v[54:55] op_sel:[0,1] op_sel_hi:[1,1]
    v_cvt_pk_bf16_f32 v248, v248, v249
    v_cvt_pk_bf16_f32 v249, v250, v251
    s_waitcnt lgkmcnt(14)
    ds_read_b64_tr_b16 v[124:125], v31 offset:14336
    s_waitcnt lgkmcnt(14)
    ds_read_b64_tr_b16 v[126:127], v31 offset:15360
    v_cvt_pk_bf16_f32 v250, v252, v253
    v_cvt_pk_bf16_f32 v251, v254, v255
    s_waitcnt lgkmcnt(14)
    ds_write_b128 v41, v[248:251] offset:15360
    s_waitcnt lgkmcnt(0)
    s_barrier
    ds_read_b128 a[128:131], v39 offset:0
    ds_read_b128 a[132:135], v39 offset:1024
    ds_read_b128 a[136:139], v39 offset:2048
    ds_read_b128 a[140:143], v39 offset:3072
    s_waitcnt lgkmcnt(3)
    v_mfma_f32_32x32x16_bf16 v[128:143], v[64:67], a[128:131], 0
    s_add_u32 m0, s5, 12288
    s_mov_b32 s6, 147456
    buffer_load_dwordx4 v12, s[20:23], s6 offen nt lds
    s_waitcnt lgkmcnt(2)
    v_mfma_f32_32x32x16_bf16 v[144:159], v[64:67], a[132:135], 0
    ds_read_b128 a[144:147], v39 offset:4096
    ds_read_b128 a[148:151], v39 offset:5120
    buffer_load_dwordx4 v13, s[20:23], s6 offen offset:1024 nt lds
    v_mfma_f32_32x32x16_bf16 v[160:175], v[68:71], a[128:131], 0
    ds_read_b128 a[152:155], v39 offset:6144
    ds_read_b128 a[156:159], v39 offset:7168
    buffer_load_dwordx4 v14, s[20:23], s6 offen offset:2048 nt lds
    v_mfma_f32_32x32x16_bf16 v[176:191], v[68:71], a[132:135], 0
    s_waitcnt lgkmcnt(5)
    v_mfma_f32_32x32x16_bf16 v[128:143], v[72:75], a[136:139], v[128:143]
    buffer_load_dwordx4 v15, s[20:23], s6 offen offset:3072 nt lds
    s_waitcnt lgkmcnt(4)
    v_mfma_f32_32x32x16_bf16 v[144:159], v[72:75], a[140:143], v[144:159]
    v_mfma_f32_32x32x16_bf16 v[160:175], v[76:79], a[136:139], v[160:175]
    v_mfma_f32_32x32x16_bf16 v[176:191], v[76:79], a[140:143], v[176:191]
    s_waitcnt lgkmcnt(3)
    v_mfma_f32_32x32x16_bf16 v[128:143], v[80:83], a[144:147], v[128:143]
    s_waitcnt lgkmcnt(2)
    v_mfma_f32_32x32x16_bf16 v[144:159], v[80:83], a[148:151], v[144:159]
    ds_read_b128 a[128:131], v39 offset:8192
    ds_read_b128 a[132:135], v39 offset:9216
    v_mfma_f32_32x32x16_bf16 v[160:175], v[84:87], a[144:147], v[160:175]
    ds_read_b128 a[136:139], v39 offset:10240
    ds_read_b128 a[140:143], v39 offset:11264
    v_mfma_f32_32x32x16_bf16 v[176:191], v[84:87], a[148:151], v[176:191]
    s_waitcnt lgkmcnt(5)
    v_mfma_f32_32x32x16_bf16 v[128:143], v[88:91], a[152:155], v[128:143]
    s_waitcnt vmcnt(20)
    ds_read_b64_tr_b16 v[192:193], v30 offset:16384
    ds_read_b64_tr_b16 v[194:195], v30 offset:17408
    ds_read_b64_tr_b16 v[196:197], v31 offset:16384
    ds_read_b64_tr_b16 v[198:199], v31 offset:17408
    s_waitcnt lgkmcnt(8)
    v_mfma_f32_32x32x16_bf16 v[144:159], v[88:91], a[156:159], v[144:159]
    ds_read_b64_tr_b16 v[200:201], v30 offset:18432
    ds_read_b64_tr_b16 v[202:203], v30 offset:19456
    ds_read_b64_tr_b16 v[204:205], v31 offset:18432
    ds_read_b64_tr_b16 v[206:207], v31 offset:19456
    v_mfma_f32_32x32x16_bf16 v[160:175], v[92:95], a[152:155], v[160:175]
    v_mfma_f32_32x32x16_bf16 v[176:191], v[92:95], a[156:159], v[176:191]
    s_waitcnt lgkmcnt(11)
    v_mfma_f32_32x32x16_bf16 v[128:143], v[96:99], a[128:131], v[128:143]
    s_waitcnt lgkmcnt(10)
    v_mfma_f32_32x32x16_bf16 v[144:159], v[96:99], a[132:135], v[144:159]
    ds_read_b128 a[144:147], v39 offset:12288
    ds_read_b128 a[148:151], v39 offset:13312
    s_waitcnt lgkmcnt(2)
    s_add_u32 m0, s5, 16384
    s_mov_b32 s6, 163840
    v_mfma_f32_32x32x16_bf16 v[160:175], v[100:103], a[128:131], v[160:175]
    ds_read_b128 a[152:155], v39 offset:14336
    ds_read_b128 a[156:159], v39 offset:15360
    buffer_load_dwordx4 v12, s[20:23], s6 offen nt lds
    v_mfma_f32_32x32x16_bf16 v[176:191], v[100:103], a[132:135], v[176:191]
    v_mfma_f32_32x32x16_bf16 v[128:143], v[104:107], a[136:139], v[128:143]
    buffer_load_dwordx4 v13, s[20:23], s6 offen offset:1024 nt lds
    v_mfma_f32_32x32x16_bf16 v[144:159], v[104:107], a[140:143], v[144:159]
    buffer_load_dwordx4 v14, s[20:23], s6 offen offset:2048 nt lds
    v_mfma_f32_32x32x16_bf16 v[160:175], v[108:111], a[136:139], v[160:175]
    buffer_load_dwordx4 v15, s[20:23], s6 offen offset:3072 nt lds
    v_mfma_f32_32x32x16_bf16 v[176:191], v[108:111], a[140:143], v[176:191]
    s_waitcnt lgkmcnt(3)
    v_mfma_f32_32x32x16_bf16 v[128:143], v[112:115], a[144:147], v[128:143]
    s_waitcnt lgkmcnt(2)
    v_mfma_f32_32x32x16_bf16 v[144:159], v[112:115], a[148:151], v[144:159]
    ds_read_b128 a[128:131], v39 offset:16384
    ds_read_b128 a[132:135], v39 offset:17408
    v_mfma_f32_32x32x16_bf16 v[160:175], v[116:119], a[144:147], v[160:175]
    ds_read_b128 a[136:139], v39 offset:18432
    ds_read_b128 a[140:143], v39 offset:19456
    v_mfma_f32_32x32x16_bf16 v[176:191], v[116:119], a[148:151], v[176:191]
    s_waitcnt lgkmcnt(5)
    v_mfma_f32_32x32x16_bf16 v[128:143], v[120:123], a[152:155], v[128:143]
    s_waitcnt lgkmcnt(4)
    v_mfma_f32_32x32x16_bf16 v[144:159], v[120:123], a[156:159], v[144:159]
    v_mfma_f32_32x32x16_bf16 v[160:175], v[124:127], a[152:155], v[160:175]
    s_waitcnt vmcnt(20)
    ds_read_b64_tr_b16 v[208:209], v30 offset:20480
    ds_read_b64_tr_b16 v[210:211], v30 offset:21504
    ds_read_b64_tr_b16 v[212:213], v31 offset:20480
    ds_read_b64_tr_b16 v[214:215], v31 offset:21504
    v_mfma_f32_32x32x16_bf16 v[176:191], v[124:127], a[156:159], v[176:191]
    ds_read_b64_tr_b16 v[216:217], v30 offset:22528
    ds_read_b64_tr_b16 v[218:219], v30 offset:23552
    ds_read_b64_tr_b16 v[220:221], v31 offset:22528
    ds_read_b64_tr_b16 v[222:223], v31 offset:23552
    s_waitcnt lgkmcnt(11)
    v_mfma_f32_32x32x16_bf16 v[128:143], v[192:195], a[128:131], v[128:143]
    s_waitcnt lgkmcnt(10)
    v_mfma_f32_32x32x16_bf16 v[144:159], v[192:195], a[132:135], v[144:159]
    ds_read_b128 a[144:147], v39 offset:20480
    ds_read_b128 a[148:151], v39 offset:21504
    v_mfma_f32_32x32x16_bf16 v[160:175], v[196:199], a[128:131], v[160:175]
    ds_read_b128 a[152:155], v39 offset:22528
    ds_read_b128 a[156:159], v39 offset:23552
    v_mfma_f32_32x32x16_bf16 v[176:191], v[196:199], a[132:135], v[176:191]
    s_waitcnt lgkmcnt(4)
    s_add_u32 m0, s5, 20480
    s_mov_b32 s6, 180224
    buffer_load_dwordx4 v12, s[20:23], s6 offen nt lds
    v_mfma_f32_32x32x16_bf16 v[128:143], v[200:203], a[136:139], v[128:143]
    v_mfma_f32_32x32x16_bf16 v[144:159], v[200:203], a[140:143], v[144:159]
    buffer_load_dwordx4 v13, s[20:23], s6 offen offset:1024 nt lds
    v_mfma_f32_32x32x16_bf16 v[160:175], v[204:207], a[136:139], v[160:175]
    buffer_load_dwordx4 v14, s[20:23], s6 offen offset:2048 nt lds
    v_mfma_f32_32x32x16_bf16 v[176:191], v[204:207], a[140:143], v[176:191]
    buffer_load_dwordx4 v15, s[20:23], s6 offen offset:3072 nt lds
    s_waitcnt lgkmcnt(3)
    v_mfma_f32_32x32x16_bf16 v[128:143], v[208:211], a[144:147], v[128:143]
    s_waitcnt lgkmcnt(2)
    v_mfma_f32_32x32x16_bf16 v[144:159], v[208:211], a[148:151], v[144:159]
    ds_read_b128 a[128:131], v39 offset:24576
    ds_read_b128 a[132:135], v39 offset:25600
    v_mfma_f32_32x32x16_bf16 v[160:175], v[212:215], a[144:147], v[160:175]
    ds_read_b128 a[136:139], v39 offset:26624
    ds_read_b128 a[140:143], v39 offset:27648
    v_mfma_f32_32x32x16_bf16 v[176:191], v[212:215], a[148:151], v[176:191]
    s_waitcnt lgkmcnt(5)
    v_mfma_f32_32x32x16_bf16 v[128:143], v[216:219], a[152:155], v[128:143]
    s_waitcnt lgkmcnt(4)
    v_mfma_f32_32x32x16_bf16 v[144:159], v[216:219], a[156:159], v[144:159]
    s_waitcnt vmcnt(20)
    ds_read_b64_tr_b16 v[192:193], v30 offset:0
    ds_read_b64_tr_b16 v[194:195], v30 offset:1024
    ds_read_b64_tr_b16 v[196:197], v31 offset:0
    ds_read_b64_tr_b16 v[198:199], v31 offset:1024
    v_mfma_f32_32x32x16_bf16 v[160:175], v[220:223], a[152:155], v[160:175]
    ds_read_b64_tr_b16 v[200:201], v30 offset:2048
    ds_read_b64_tr_b16 v[202:203], v30 offset:3072
    ds_read_b64_tr_b16 v[204:205], v31 offset:2048
    ds_read_b64_tr_b16 v[206:207], v31 offset:3072
    v_mfma_f32_32x32x16_bf16 v[176:191], v[220:223], a[156:159], v[176:191]
    s_waitcnt lgkmcnt(6)
    v_mfma_f32_32x32x16_bf16 v[128:143], v[192:195], a[128:131], v[128:143]
    v_mfma_f32_32x32x16_bf16 v[144:159], v[192:195], a[132:135], v[144:159]
    ds_read_b128 a[144:147], v39 offset:28672
    ds_read_b128 a[148:151], v39 offset:29696
    s_waitcnt lgkmcnt(6)
    v_mfma_f32_32x32x16_bf16 v[160:175], v[196:199], a[128:131], v[160:175]
    ds_read_b128 a[152:155], v39 offset:30720
    ds_read_b128 a[156:159], v39 offset:31744
    s_waitcnt lgkmcnt(4)
    s_add_u32 m0, s5, 0
    s_mov_b32 s6, 196608
    v_mfma_f32_32x32x16_bf16 v[176:191], v[196:199], a[132:135], v[176:191]
    buffer_load_dwordx4 v12, s[20:23], s6 offen nt lds
    v_mfma_f32_32x32x16_bf16 v[128:143], v[200:203], a[136:139], v[128:143]
    buffer_load_dwordx4 v13, s[20:23], s6 offen offset:1024 nt lds
    v_mfma_f32_32x32x16_bf16 v[144:159], v[200:203], a[140:143], v[144:159]
    buffer_load_dwordx4 v14, s[20:23], s6 offen offset:2048 nt lds
    s_waitcnt vmcnt(19)
    ds_read_b64_tr_b16 v[208:209], v30 offset:4096
    ds_read_b64_tr_b16 v[210:211], v30 offset:5120
    ds_read_b64_tr_b16 v[212:213], v31 offset:4096
    v_mfma_f32_32x32x16_bf16 v[160:175], v[204:207], a[136:139], v[160:175]
    buffer_load_dwordx4 v15, s[20:23], s6 offen offset:3072 nt lds
    ds_read_b64_tr_b16 v[214:215], v31 offset:5120
    ds_read_b64_tr_b16 v[216:217], v30 offset:6144
    ds_read_b64_tr_b16 v[218:219], v30 offset:7168
    v_mfma_f32_32x32x16_bf16 v[176:191], v[204:207], a[140:143], v[176:191]
    ds_read_b64_tr_b16 v[220:221], v31 offset:6144
    ds_read_b64_tr_b16 v[222:223], v31 offset:7168
    s_waitcnt lgkmcnt(6)
    v_mfma_f32_32x32x16_bf16 v[128:143], v[208:211], a[144:147], v[128:143]
    v_mfma_f32_32x32x16_bf16 v[144:159], v[208:211], a[148:151], v[144:159]
    ds_read_b128 a[128:131], v39 offset:32768
    ds_read_b128 a[132:135], v39 offset:33792
    s_waitcnt lgkmcnt(6)
    v_mfma_f32_32x32x16_bf16 v[160:175], v[212:215], a[144:147], v[160:175]
    ds_read_b128 a[136:139], v39 offset:34816
    ds_read_b128 a[140:143], v39 offset:35840
    v_mfma_f32_32x32x16_bf16 v[176:191], v[212:215], a[148:151], v[176:191]
    s_waitcnt lgkmcnt(4)
    s_add_u32 m0, s5, 4096
    s_mov_b32 s6, 212992
    buffer_load_dwordx4 v12, s[20:23], s6 offen nt lds
    v_mfma_f32_32x32x16_bf16 v[128:143], v[216:219], a[152:155], v[128:143]
    v_mfma_f32_32x32x16_bf16 v[144:159], v[216:219], a[156:159], v[144:159]
    buffer_load_dwordx4 v13, s[20:23], s6 offen offset:1024 nt lds
    s_waitcnt vmcnt(18)
    ds_read_b64_tr_b16 v[192:193], v30 offset:8192
    ds_read_b64_tr_b16 v[194:195], v30 offset:9216
    ds_read_b64_tr_b16 v[196:197], v31 offset:8192
    v_mfma_f32_32x32x16_bf16 v[160:175], v[220:223], a[152:155], v[160:175]
    buffer_load_dwordx4 v14, s[20:23], s6 offen offset:2048 nt lds
    ds_read_b64_tr_b16 v[198:199], v31 offset:9216
    ds_read_b64_tr_b16 v[200:201], v30 offset:10240
    ds_read_b64_tr_b16 v[202:203], v30 offset:11264
    v_mfma_f32_32x32x16_bf16 v[176:191], v[220:223], a[156:159], v[176:191]
    buffer_load_dwordx4 v15, s[20:23], s6 offen offset:3072 nt lds
    ds_read_b64_tr_b16 v[204:205], v31 offset:10240
    ds_read_b64_tr_b16 v[206:207], v31 offset:11264
    s_waitcnt lgkmcnt(6)
    v_mfma_f32_32x32x16_bf16 v[128:143], v[192:195], a[128:131], v[128:143]
    v_mfma_f32_32x32x16_bf16 v[144:159], v[192:195], a[132:135], v[144:159]
    ds_read_b128 a[144:147], v39 offset:36864
    ds_read_b128 a[148:151], v39 offset:37888
    s_waitcnt lgkmcnt(6)
    v_mfma_f32_32x32x16_bf16 v[160:175], v[196:199], a[128:131], v[160:175]
    ds_read_b128 a[152:155], v39 offset:38912
    ds_read_b128 a[156:159], v39 offset:39936
    v_mfma_f32_32x32x16_bf16 v[176:191], v[196:199], a[132:135], v[176:191]
    s_waitcnt lgkmcnt(4)
    s_add_u32 m0, s5, 8192
    s_mov_b32 s6, 229376
    buffer_load_dwordx4 v12, s[20:23], s6 offen nt lds
    v_mfma_f32_32x32x16_bf16 v[128:143], v[200:203], a[136:139], v[128:143]
    v_mfma_f32_32x32x16_bf16 v[144:159], v[200:203], a[140:143], v[144:159]
    buffer_load_dwordx4 v13, s[20:23], s6 offen offset:1024 nt lds
    s_waitcnt vmcnt(18)
    ds_read_b64_tr_b16 v[208:209], v30 offset:12288
    ds_read_b64_tr_b16 v[210:211], v30 offset:13312
    ds_read_b64_tr_b16 v[212:213], v31 offset:12288
    v_mfma_f32_32x32x16_bf16 v[160:175], v[204:207], a[136:139], v[160:175]
    buffer_load_dwordx4 v14, s[20:23], s6 offen offset:2048 nt lds
    ds_read_b64_tr_b16 v[214:215], v31 offset:13312
    ds_read_b64_tr_b16 v[216:217], v30 offset:14336
    ds_read_b64_tr_b16 v[218:219], v30 offset:15360
    v_mfma_f32_32x32x16_bf16 v[176:191], v[204:207], a[140:143], v[176:191]
    buffer_load_dwordx4 v15, s[20:23], s6 offen offset:3072 nt lds
    ds_read_b64_tr_b16 v[220:221], v31 offset:14336
    ds_read_b64_tr_b16 v[222:223], v31 offset:15360
    s_waitcnt lgkmcnt(6)
    v_mfma_f32_32x32x16_bf16 v[128:143], v[208:211], a[144:147], v[128:143]
    v_mfma_f32_32x32x16_bf16 v[144:159], v[208:211], a[148:151], v[144:159]
    ds_read_b128 a[128:131], v39 offset:40960
    ds_read_b128 a[132:135], v39 offset:41984
    s_waitcnt lgkmcnt(6)
    v_mfma_f32_32x32x16_bf16 v[160:175], v[212:215], a[144:147], v[160:175]
    ds_read_b128 a[136:139], v39 offset:43008
    ds_read_b128 a[140:143], v39 offset:44032
    v_mfma_f32_32x32x16_bf16 v[176:191], v[212:215], a[148:151], v[176:191]
    s_waitcnt lgkmcnt(4)
    s_add_u32 m0, s5, 12288
    s_mov_b32 s6, 245760
    buffer_load_dwordx4 v12, s[20:23], s6 offen nt lds
    v_mfma_f32_32x32x16_bf16 v[128:143], v[216:219], a[152:155], v[128:143]
    v_mfma_f32_32x32x16_bf16 v[144:159], v[216:219], a[156:159], v[144:159]
    buffer_load_dwordx4 v13, s[20:23], s6 offen offset:1024 nt lds
    s_waitcnt vmcnt(18)
    ds_read_b64_tr_b16 v[192:193], v30 offset:16384
    ds_read_b64_tr_b16 v[194:195], v30 offset:17408
    ds_read_b64_tr_b16 v[196:197], v31 offset:16384
    v_mfma_f32_32x32x16_bf16 v[160:175], v[220:223], a[152:155], v[160:175]
    buffer_load_dwordx4 v14, s[20:23], s6 offen offset:2048 nt lds
    ds_read_b64_tr_b16 v[198:199], v31 offset:17408
    ds_read_b64_tr_b16 v[200:201], v30 offset:18432
    ds_read_b64_tr_b16 v[202:203], v30 offset:19456
    v_mfma_f32_32x32x16_bf16 v[176:191], v[220:223], a[156:159], v[176:191]
    buffer_load_dwordx4 v15, s[20:23], s6 offen offset:3072 nt lds
    ds_read_b64_tr_b16 v[204:205], v31 offset:18432
    ds_read_b64_tr_b16 v[206:207], v31 offset:19456
    s_waitcnt lgkmcnt(6)
    v_mfma_f32_32x32x16_bf16 v[128:143], v[192:195], a[128:131], v[128:143]
    v_mfma_f32_32x32x16_bf16 v[144:159], v[192:195], a[132:135], v[144:159]
    ds_read_b128 a[144:147], v39 offset:45056
    ds_read_b128 a[148:151], v39 offset:46080
    s_waitcnt lgkmcnt(6)
    v_mfma_f32_32x32x16_bf16 v[160:175], v[196:199], a[128:131], v[160:175]
    ds_read_b128 a[152:155], v39 offset:47104
    ds_read_b128 a[156:159], v39 offset:48128
    v_mfma_f32_32x32x16_bf16 v[176:191], v[196:199], a[132:135], v[176:191]
    s_waitcnt lgkmcnt(6)
    v_mfma_f32_32x32x16_bf16 v[128:143], v[200:203], a[136:139], v[128:143]
    v_mfma_f32_32x32x16_bf16 v[144:159], v[200:203], a[140:143], v[144:159]
    s_waitcnt vmcnt(16)
    ds_read_b64_tr_b16 v[208:209], v30 offset:20480
    ds_read_b64_tr_b16 v[210:211], v30 offset:21504
    ds_read_b64_tr_b16 v[212:213], v31 offset:20480
    ds_read_b64_tr_b16 v[214:215], v31 offset:21504
    s_waitcnt lgkmcnt(8)
    v_mfma_f32_32x32x16_bf16 v[160:175], v[204:207], a[136:139], v[160:175]
    ds_read_b64_tr_b16 v[216:217], v30 offset:22528
    ds_read_b64_tr_b16 v[218:219], v30 offset:23552
    ds_read_b64_tr_b16 v[220:221], v31 offset:22528
    ds_read_b64_tr_b16 v[222:223], v31 offset:23552
    v_mfma_f32_32x32x16_bf16 v[176:191], v[204:207], a[140:143], v[176:191]
    s_waitcnt lgkmcnt(6)
    v_mfma_f32_32x32x16_bf16 v[128:143], v[208:211], a[144:147], v[128:143]
    v_mfma_f32_32x32x16_bf16 v[144:159], v[208:211], a[148:151], v[144:159]
    ds_read_b128 a[128:131], v39 offset:49152
    ds_read_b128 a[132:135], v39 offset:50176
    s_waitcnt lgkmcnt(6)
    v_mfma_f32_32x32x16_bf16 v[160:175], v[212:215], a[144:147], v[160:175]
    ds_read_b128 a[136:139], v39 offset:51200
    ds_read_b128 a[140:143], v39 offset:52224
    s_waitcnt lgkmcnt(4)
    s_add_u32 m0, s5, 16384
    s_add_u32 s6, s88, 0
    v_mfma_f32_32x32x16_bf16 v[176:191], v[212:215], a[148:151], v[176:191]
    buffer_load_dwordx4 v16, s[24:27], s6 offen lds
    v_mfma_f32_32x32x16_bf16 v[128:143], v[216:219], a[152:155], v[128:143]
    buffer_load_dwordx4 v17, s[24:27], s6 offen offset:1024 lds
    v_mfma_f32_32x32x16_bf16 v[144:159], v[216:219], a[156:159], v[144:159]
    buffer_load_dwordx4 v18, s[24:27], s6 offen offset:2048 lds
    s_waitcnt vmcnt(15)
    ds_read_b64_tr_b16 v[192:193], v30 offset:0
    ds_read_b64_tr_b16 v[194:195], v30 offset:1024
    ds_read_b64_tr_b16 v[196:197], v31 offset:0
    v_mfma_f32_32x32x16_bf16 v[160:175], v[220:223], a[152:155], v[160:175]
    buffer_load_dwordx4 v19, s[24:27], s6 offen offset:3072 lds
    ds_read_b64_tr_b16 v[198:199], v31 offset:1024
    ds_read_b64_tr_b16 v[200:201], v30 offset:2048
    ds_read_b64_tr_b16 v[202:203], v30 offset:3072
    v_mfma_f32_32x32x16_bf16 v[176:191], v[220:223], a[156:159], v[176:191]
    s_add_u32 m0, s5, 20480
    s_add_u32 s6, s88, 14336
    buffer_load_dwordx4 v16, s[24:27], s6 offen lds
    ds_read_b64_tr_b16 v[204:205], v31 offset:2048
    ds_read_b64_tr_b16 v[206:207], v31 offset:3072
    s_waitcnt lgkmcnt(6)
    v_mfma_f32_32x32x16_bf16 v[128:143], v[192:195], a[128:131], v[128:143]
    buffer_load_dwordx4 v17, s[24:27], s6 offen offset:1024 lds
    v_mfma_f32_32x32x16_bf16 v[144:159], v[192:195], a[132:135], v[144:159]
    ds_read_b128 a[144:147], v39 offset:53248
    ds_read_b128 a[148:151], v39 offset:54272
    buffer_load_dwordx4 v18, s[24:27], s6 offen offset:2048 lds
    s_waitcnt lgkmcnt(6)
    v_mfma_f32_32x32x16_bf16 v[160:175], v[196:199], a[128:131], v[160:175]
    ds_read_b128 a[152:155], v39 offset:55296
    ds_read_b128 a[156:159], v39 offset:56320
    buffer_load_dwordx4 v19, s[24:27], s6 offen offset:3072 lds
    v_mfma_f32_32x32x16_bf16 v[176:191], v[196:199], a[132:135], v[176:191]
    s_waitcnt lgkmcnt(6)
    v_mfma_f32_32x32x16_bf16 v[128:143], v[200:203], a[136:139], v[128:143]
    v_mfma_f32_32x32x16_bf16 v[144:159], v[200:203], a[140:143], v[144:159]
    s_waitcnt vmcnt(16)
    ds_read_b64_tr_b16 v[208:209], v30 offset:4096
    ds_read_b64_tr_b16 v[210:211], v30 offset:5120
    ds_read_b64_tr_b16 v[212:213], v31 offset:4096
    ds_read_b64_tr_b16 v[214:215], v31 offset:5120
    s_waitcnt lgkmcnt(8)
    v_mfma_f32_32x32x16_bf16 v[160:175], v[204:207], a[136:139], v[160:175]
    ds_read_b64_tr_b16 v[216:217], v30 offset:6144
    ds_read_b64_tr_b16 v[218:219], v30 offset:7168
    ds_read_b64_tr_b16 v[220:221], v31 offset:6144
    ds_read_b64_tr_b16 v[222:223], v31 offset:7168
    v_mfma_f32_32x32x16_bf16 v[176:191], v[204:207], a[140:143], v[176:191]
    s_waitcnt lgkmcnt(6)
    v_mfma_f32_32x32x16_bf16 v[128:143], v[208:211], a[144:147], v[128:143]
    v_mfma_f32_32x32x16_bf16 v[144:159], v[208:211], a[148:151], v[144:159]
    ds_read_b128 a[128:131], v39 offset:57344
    ds_read_b128 a[132:135], v39 offset:58368
    s_waitcnt lgkmcnt(6)
    v_mfma_f32_32x32x16_bf16 v[160:175], v[212:215], a[144:147], v[160:175]
    ds_read_b128 a[136:139], v39 offset:59392
    ds_read_b128 a[140:143], v39 offset:60416
    s_waitcnt lgkmcnt(4)
    s_add_u32 m0, s5, 0
    s_add_u32 s6, s89, 0
    v_mfma_f32_32x32x16_bf16 v[176:191], v[212:215], a[148:151], v[176:191]
    buffer_load_dwordx4 v16, s[24:27], s6 offen lds
    v_mfma_f32_32x32x16_bf16 v[128:143], v[216:219], a[152:155], v[128:143]
    buffer_load_dwordx4 v17, s[24:27], s6 offen offset:1024 lds
    v_mfma_f32_32x32x16_bf16 v[144:159], v[216:219], a[156:159], v[144:159]
    buffer_load_dwordx4 v18, s[24:27], s6 offen offset:2048 lds
    s_waitcnt vmcnt(15)
    ds_read_b64_tr_b16 v[192:193], v30 offset:8192
    ds_read_b64_tr_b16 v[194:195], v30 offset:9216
    ds_read_b64_tr_b16 v[196:197], v31 offset:8192
    v_mfma_f32_32x32x16_bf16 v[160:175], v[220:223], a[152:155], v[160:175]
    buffer_load_dwordx4 v19, s[24:27], s6 offen offset:3072 lds
    ds_read_b64_tr_b16 v[198:199], v31 offset:9216
    ds_read_b64_tr_b16 v[200:201], v30 offset:10240
    ds_read_b64_tr_b16 v[202:203], v30 offset:11264
    v_mfma_f32_32x32x16_bf16 v[176:191], v[220:223], a[156:159], v[176:191]
    s_add_u32 m0, s5, 4096
    s_add_u32 s6, s89, 14336
    buffer_load_dwordx4 v16, s[24:27], s6 offen lds
    ds_read_b64_tr_b16 v[204:205], v31 offset:10240
    ds_read_b64_tr_b16 v[206:207], v31 offset:11264
    s_waitcnt lgkmcnt(6)
    v_mfma_f32_32x32x16_bf16 v[128:143], v[192:195], a[128:131], v[128:143]
    buffer_load_dwordx4 v17, s[24:27], s6 offen offset:1024 lds
    v_mfma_f32_32x32x16_bf16 v[144:159], v[192:195], a[132:135], v[144:159]
    ds_read_b128 a[144:147], v39 offset:61440
    ds_read_b128 a[148:151], v39 offset:62464
    buffer_load_dwordx4 v18, s[24:27], s6 offen offset:2048 lds
    s_waitcnt lgkmcnt(6)
    v_mfma_f32_32x32x16_bf16 v[160:175], v[196:199], a[128:131], v[160:175]
    ds_read_b128 a[152:155], v39 offset:63488
    ds_read_b128 a[156:159], v39 offset:64512
    buffer_load_dwordx4 v19, s[24:27], s6 offen offset:3072 lds
    v_mfma_f32_32x32x16_bf16 v[176:191], v[196:199], a[132:135], v[176:191]
    s_waitcnt lgkmcnt(6)
    v_mfma_f32_32x32x16_bf16 v[128:143], v[200:203], a[136:139], v[128:143]
    v_mfma_f32_32x32x16_bf16 v[144:159], v[200:203], a[140:143], v[144:159]
    s_waitcnt vmcnt(16)
    ds_read_b64_tr_b16 v[208:209], v30 offset:12288
    ds_read_b64_tr_b16 v[210:211], v30 offset:13312
    ds_read_b64_tr_b16 v[212:213], v31 offset:12288
    ds_read_b64_tr_b16 v[214:215], v31 offset:13312
    s_waitcnt lgkmcnt(8)
    v_mfma_f32_32x32x16_bf16 v[160:175], v[204:207], a[136:139], v[160:175]
    ds_read_b64_tr_b16 v[216:217], v30 offset:14336
    ds_read_b64_tr_b16 v[218:219], v30 offset:15360
    ds_read_b64_tr_b16 v[220:221], v31 offset:14336
    ds_read_b64_tr_b16 v[222:223], v31 offset:15360
    v_mfma_f32_32x32x16_bf16 v[176:191], v[204:207], a[140:143], v[176:191]
    s_waitcnt lgkmcnt(6)
    v_mfma_f32_32x32x16_bf16 v[128:143], v[208:211], a[144:147], v[128:143]
    v_mfma_f32_32x32x16_bf16 v[144:159], v[208:211], a[148:151], v[144:159]
    s_waitcnt lgkmcnt(4)
    v_mfma_f32_32x32x16_bf16 v[160:175], v[212:215], a[144:147], v[160:175]
    s_waitcnt lgkmcnt(0)
    s_add_u32 m0, s5, 8192
    s_add_u32 s6, s90, 0
    buffer_load_dwordx4 v16, s[24:27], s6 offen lds
    v_mfma_f32_32x32x16_bf16 v[176:191], v[212:215], a[148:151], v[176:191]
    v_mfma_f32_32x32x16_bf16 v[128:143], v[216:219], a[152:155], v[128:143]
    buffer_load_dwordx4 v17, s[24:27], s6 offen offset:1024 lds
    v_mfma_f32_32x32x16_bf16 v[144:159], v[216:219], a[156:159], v[144:159]
    buffer_load_dwordx4 v18, s[24:27], s6 offen offset:2048 lds
    s_waitcnt vmcnt(11)
    ds_read_b64_tr_b16 v[64:65], v32 offset:16384
    ds_read_b64_tr_b16 v[66:67], v32 offset:17408
    ds_read_b64_tr_b16 v[68:69], v33 offset:16384
    v_mfma_f32_32x32x16_bf16 v[160:175], v[220:223], a[152:155], v[160:175]
    buffer_load_dwordx4 v19, s[24:27], s6 offen offset:3072 lds
    ds_read_b64_tr_b16 v[70:71], v33 offset:17408
    ds_read_b64_tr_b16 v[72:73], v34 offset:16384
    ds_read_b64_tr_b16 v[74:75], v34 offset:17408
    v_mfma_f32_32x32x16_bf16 v[176:191], v[220:223], a[156:159], v[176:191]
    s_add_u32 m0, s5, 12288
    s_add_u32 s6, s90, 14336
    buffer_load_dwordx4 v16, s[24:27], s6 offen lds
    ds_read_b64_tr_b16 v[76:77], v35 offset:16384
    v_cvt_pk_bf16_f32 v128, v128, v129
    v_cvt_pk_bf16_f32 v129, v130, v131
    ds_read_b64_tr_b16 v[78:79], v35 offset:17408
    ds_read_b64_tr_b16 v[80:81], v36 offset:16384
    ds_read_b64_tr_b16 v[82:83], v36 offset:17408
    v_cvt_pk_bf16_f32 v130, v132, v133
    v_cvt_pk_bf16_f32 v131, v134, v135
    v_cvt_pk_bf16_f32 v136, v136, v137
    v_cvt_pk_bf16_f32 v137, v138, v139
    buffer_load_dwordx4 v17, s[24:27], s6 offen offset:1024 lds
    ds_read_b64_tr_b16 v[84:85], v37 offset:16384
    ds_read_b64_tr_b16 v[86:87], v37 offset:17408
    v_cvt_pk_bf16_f32 v138, v140, v141
    v_cvt_pk_bf16_f32 v139, v142, v143
    v_cvt_pk_bf16_f32 v144, v144, v145
    v_cvt_pk_bf16_f32 v145, v146, v147
    buffer_load_dwordx4 v18, s[24:27], s6 offen offset:2048 lds
    ds_read_b64_tr_b16 v[88:89], v38 offset:16384
    ds_read_b64_tr_b16 v[90:91], v38 offset:17408
    v_cvt_pk_bf16_f32 v146, v148, v149
    v_cvt_pk_bf16_f32 v147, v150, v151
    v_cvt_pk_bf16_f32 v152, v152, v153
    v_cvt_pk_bf16_f32 v153, v154, v155
    buffer_load_dwordx4 v19, s[24:27], s6 offen offset:3072 lds
    v_cvt_pk_bf16_f32 v154, v156, v157
    v_cvt_pk_bf16_f32 v155, v158, v159
    v_cvt_pk_bf16_f32 v160, v160, v161
    v_cvt_pk_bf16_f32 v161, v162, v163
    v_cvt_pk_bf16_f32 v162, v164, v165
    v_cvt_pk_bf16_f32 v163, v166, v167
    v_cvt_pk_bf16_f32 v168, v168, v169
    v_cvt_pk_bf16_f32 v169, v170, v171
    v_cvt_pk_bf16_f32 v170, v172, v173
    v_cvt_pk_bf16_f32 v171, v174, v175
    v_cvt_pk_bf16_f32 v176, v176, v177
    v_cvt_pk_bf16_f32 v177, v178, v179
    v_cvt_pk_bf16_f32 v178, v180, v181
    v_cvt_pk_bf16_f32 v179, v182, v183
    v_cvt_pk_bf16_f32 v184, v184, v185
    v_cvt_pk_bf16_f32 v185, v186, v187
    v_cvt_pk_bf16_f32 v186, v188, v189
    v_cvt_pk_bf16_f32 v187, v190, v191
    s_waitcnt lgkmcnt(0)
    s_barrier
    ds_write_b32 v43, v22 offset:32768
    ds_write_b128 v42, v[128:131] offset:0
    ds_write_b128 v42, v[136:139] offset:512
    ds_write_b128 v42, v[144:147] offset:2048
    ds_write_b128 v42, v[152:155] offset:2560
    ds_write_b128 v45, v[160:163] offset:0
    ds_write_b128 v45, v[168:171] offset:512
    ds_write_b128 v45, v[176:179] offset:2048
    ds_write_b128 v45, v[184:187] offset:2560
    s_add_u32 m0, s5, 16384
    s_add_u32 s6, s91, 0
    buffer_load_dwordx4 v16, s[24:27], s6 offen lds
    s_waitcnt lgkmcnt(0)
    s_barrier
    ds_read_b128 a[128:131], v39 offset:0
    ds_read_b128 a[132:135], v39 offset:1024
    ds_read_b128 a[136:139], v39 offset:2048
    ds_read_b128 a[140:143], v39 offset:3072
    ds_read_b128 v[48:51], v46 offset:32768
    ds_read_b128 v[52:55], v46 offset:33024
    ds_read_b128 v[56:59], v46 offset:33280
    ds_read_b128 v[60:63], v46 offset:33536
    s_waitcnt lgkmcnt(7)
    v_mfma_f32_16x16x32_bf16 v[128:131], v[64:67], a[128:131], 0
    buffer_load_dwordx4 v17, s[24:27], s6 offen offset:1024 lds
    s_waitcnt lgkmcnt(6)
    v_mfma_f32_16x16x32_bf16 v[132:135], v[64:67], a[132:135], 0
    s_waitcnt lgkmcnt(5)
    v_mfma_f32_16x16x32_bf16 v[136:139], v[64:67], a[136:139], 0
    ds_read_b128 a[144:147], v39 offset:4096
    buffer_load_dwordx4 v18, s[24:27], s6 offen offset:2048 lds
    s_waitcnt lgkmcnt(5)
    v_mfma_f32_16x16x32_bf16 v[140:143], v[64:67], a[140:143], 0
    v_mfma_f32_16x16x32_bf16 v[144:147], v[68:71], a[128:131], 0
    ds_read_b128 a[148:151], v39 offset:5120
    buffer_load_dwordx4 v19, s[24:27], s6 offen offset:3072 lds
    v_mfma_f32_16x16x32_bf16 v[148:151], v[68:71], a[132:135], 0
    s_waitcnt vmcnt(12)
    ds_read_b64_tr_b16 v[96:97], v32 offset:0
    ds_read_b64_tr_b16 v[98:99], v32 offset:1024
    v_mfma_f32_16x16x32_bf16 v[152:155], v[68:71], a[136:139], 0
    ds_read_b128 a[152:155], v39 offset:6144
    s_add_u32 m0, s5, 20480
    s_add_u32 s6, s91, 14336
    v_mfma_f32_16x16x32_bf16 v[156:159], v[68:71], a[140:143], 0
    buffer_load_dwordx4 v16, s[24:27], s6 offen lds
    ds_read_b64_tr_b16 v[100:101], v33 offset:0
    v_mfma_f32_16x16x32_bf16 v[160:163], v[72:75], a[128:131], 0
    ds_read_b128 a[156:159], v39 offset:7168
    buffer_load_dwordx4 v17, s[24:27], s6 offen offset:1024 lds
    v_mfma_f32_16x16x32_bf16 v[164:167], v[72:75], a[132:135], 0
    ds_read_b64_tr_b16 v[102:103], v33 offset:1024
    ds_read_b64_tr_b16 v[104:105], v34 offset:0
    v_mfma_f32_16x16x32_bf16 v[168:171], v[72:75], a[136:139], 0
    s_waitcnt lgkmcnt(12)
    v_add_f32 v48, v48, v49
    buffer_load_dwordx4 v18, s[24:27], s6 offen offset:2048 lds
    v_mfma_f32_16x16x32_bf16 v[172:175], v[72:75], a[140:143], 0
    ds_read_b64_tr_b16 v[106:107], v34 offset:1024
    ds_read_b64_tr_b16 v[108:109], v35 offset:0
    v_mfma_f32_16x16x32_bf16 v[176:179], v[76:79], a[128:131], 0
    v_add_f32 v50, v50, v51
    buffer_load_dwordx4 v19, s[24:27], s6 offen offset:3072 lds
    v_mfma_f32_16x16x32_bf16 v[180:183], v[76:79], a[132:135], 0
    ds_read_b64_tr_b16 v[110:111], v35 offset:1024
    s_waitcnt lgkmcnt(14)
    ds_read_b64_tr_b16 v[112:113], v36 offset:0
    v_mfma_f32_16x16x32_bf16 v[184:187], v[76:79], a[136:139], 0
    v_add_f32 v48, v48, v50
    s_waitcnt lgkmcnt(14)
    ds_read_b64_tr_b16 v[114:115], v36 offset:1024
    v_mfma_f32_16x16x32_bf16 v[188:191], v[76:79], a[140:143], 0
    s_waitcnt lgkmcnt(14)
    ds_read_b64_tr_b16 v[116:117], v37 offset:0
    s_waitcnt lgkmcnt(14)
    ds_read_b64_tr_b16 v[118:119], v37 offset:1024
    v_mfma_f32_16x16x32_bf16 v[192:195], v[80:83], a[128:131], 0
    v_rcp_f32 v48, v48
    s_waitcnt lgkmcnt(14)
    ds_read_b64_tr_b16 v[120:121], v38 offset:0
    v_mfma_f32_16x16x32_bf16 v[196:199], v[80:83], a[132:135], 0
    s_waitcnt lgkmcnt(14)
    ds_read_b64_tr_b16 v[122:123], v38 offset:1024
    v_mfma_f32_16x16x32_bf16 v[200:203], v[80:83], a[136:139], 0
    v_add_f32 v52, v52, v53
    v_mfma_f32_16x16x32_bf16 v[204:207], v[80:83], a[140:143], 0
    v_mfma_f32_16x16x32_bf16 v[208:211], v[84:87], a[128:131], 0
    v_add_f32 v54, v54, v55
    v_mfma_f32_16x16x32_bf16 v[212:215], v[84:87], a[132:135], 0
    v_mfma_f32_16x16x32_bf16 v[216:219], v[84:87], a[136:139], 0
    v_add_f32 v52, v52, v54
    v_mfma_f32_16x16x32_bf16 v[220:223], v[84:87], a[140:143], 0
    v_mfma_f32_16x16x32_bf16 v[224:227], v[88:91], a[128:131], 0
    v_rcp_f32 v52, v52
    s_waitcnt lgkmcnt(0)
    s_add_u32 m0, s5, 0
    s_add_u32 s6, s92, 0
    v_mfma_f32_16x16x32_bf16 v[228:231], v[88:91], a[132:135], 0
    buffer_load_dwordx4 v16, s[24:27], s6 offen lds
    v_mfma_f32_16x16x32_bf16 v[232:235], v[88:91], a[136:139], 0
    v_add_f32 v56, v56, v57
    v_mfma_f32_16x16x32_bf16 v[236:239], v[88:91], a[140:143], 0
    buffer_load_dwordx4 v17, s[24:27], s6 offen offset:1024 lds
    v_add_f32 v58, v58, v59
    v_add_f32 v56, v56, v58
    v_rcp_f32 v56, v56
    v_add_f32 v60, v60, v61
    v_add_f32 v62, v62, v63
    v_add_f32 v60, v60, v62
    v_rcp_f32 v60, v60
    v_mfma_f32_16x16x32_bf16 v[128:131], v[96:99], a[144:147], v[128:131]
    buffer_load_dwordx4 v18, s[24:27], s6 offen offset:2048 lds
    v_mfma_f32_16x16x32_bf16 v[132:135], v[96:99], a[148:151], v[132:135]
    v_mfma_f32_16x16x32_bf16 v[136:139], v[96:99], a[152:155], v[136:139]
    ds_read_b128 a[128:131], v39 offset:8192
    buffer_load_dwordx4 v19, s[24:27], s6 offen offset:3072 lds
    v_mfma_f32_16x16x32_bf16 v[140:143], v[96:99], a[156:159], v[140:143]
    v_mfma_f32_16x16x32_bf16 v[144:147], v[100:103], a[144:147], v[144:147]
    ds_read_b128 a[132:135], v39 offset:9216
    s_add_u32 m0, s5, 4096
    s_add_u32 s6, s92, 14336
    v_mfma_f32_16x16x32_bf16 v[148:151], v[100:103], a[148:151], v[148:151]
    buffer_load_dwordx4 v16, s[24:27], s6 offen lds
    v_mfma_f32_16x16x32_bf16 v[152:155], v[100:103], a[152:155], v[152:155]
    ds_read_b128 a[136:139], v39 offset:10240
    v_mfma_f32_16x16x32_bf16 v[156:159], v[100:103], a[156:159], v[156:159]
    buffer_load_dwordx4 v17, s[24:27], s6 offen offset:1024 lds
    v_mfma_f32_16x16x32_bf16 v[160:163], v[104:107], a[144:147], v[160:163]
    ds_read_b128 a[140:143], v39 offset:11264
    v_mfma_f32_16x16x32_bf16 v[164:167], v[104:107], a[148:151], v[164:167]
    buffer_load_dwordx4 v18, s[24:27], s6 offen offset:2048 lds
    v_mfma_f32_16x16x32_bf16 v[168:171], v[104:107], a[152:155], v[168:171]
    v_mfma_f32_16x16x32_bf16 v[172:175], v[104:107], a[156:159], v[172:175]
    buffer_load_dwordx4 v19, s[24:27], s6 offen offset:3072 lds
    v_mfma_f32_16x16x32_bf16 v[176:179], v[108:111], a[144:147], v[176:179]
    v_mfma_f32_16x16x32_bf16 v[180:183], v[108:111], a[148:151], v[180:183]
    v_mfma_f32_16x16x32_bf16 v[184:187], v[108:111], a[152:155], v[184:187]
    s_waitcnt vmcnt(16)
    ds_read_b64_tr_b16 v[64:65], v32 offset:8192
    ds_read_b64_tr_b16 v[66:67], v32 offset:9216
    v_mfma_f32_16x16x32_bf16 v[188:191], v[108:111], a[156:159], v[188:191]
    ds_read_b64_tr_b16 v[68:69], v33 offset:8192
    ds_read_b64_tr_b16 v[70:71], v33 offset:9216
    v_mfma_f32_16x16x32_bf16 v[192:195], v[112:115], a[144:147], v[192:195]
    ds_read_b64_tr_b16 v[72:73], v34 offset:8192
    ds_read_b64_tr_b16 v[74:75], v34 offset:9216
    v_mfma_f32_16x16x32_bf16 v[196:199], v[112:115], a[148:151], v[196:199]
    ds_read_b64_tr_b16 v[76:77], v35 offset:8192
    ds_read_b64_tr_b16 v[78:79], v35 offset:9216
    v_mfma_f32_16x16x32_bf16 v[200:203], v[112:115], a[152:155], v[200:203]
    ds_read_b64_tr_b16 v[80:81], v36 offset:8192
    ds_read_b64_tr_b16 v[82:83], v36 offset:9216
    v_mfma_f32_16x16x32_bf16 v[204:207], v[112:115], a[156:159], v[204:207]
    ds_read_b64_tr_b16 v[84:85], v37 offset:8192
    s_waitcnt lgkmcnt(14)
    ds_read_b64_tr_b16 v[86:87], v37 offset:9216
    v_mfma_f32_16x16x32_bf16 v[208:211], v[116:119], a[144:147], v[208:211]
    s_waitcnt lgkmcnt(14)
    ds_read_b64_tr_b16 v[88:89], v38 offset:8192
    s_waitcnt lgkmcnt(14)
    ds_read_b64_tr_b16 v[90:91], v38 offset:9216
    v_mfma_f32_16x16x32_bf16 v[212:215], v[116:119], a[148:151], v[212:215]
    v_mfma_f32_16x16x32_bf16 v[216:219], v[116:119], a[152:155], v[216:219]
    v_mfma_f32_16x16x32_bf16 v[220:223], v[116:119], a[156:159], v[220:223]
    v_mfma_f32_16x16x32_bf16 v[224:227], v[120:123], a[144:147], v[224:227]
    v_mfma_f32_16x16x32_bf16 v[228:231], v[120:123], a[148:151], v[228:231]
    v_mfma_f32_16x16x32_bf16 v[232:235], v[120:123], a[152:155], v[232:235]
    v_mfma_f32_16x16x32_bf16 v[236:239], v[120:123], a[156:159], v[236:239]
    s_waitcnt lgkmcnt(0)
    s_add_u32 m0, s5, 8192
    s_add_u32 s6, s93, 0
    v_mfma_f32_16x16x32_bf16 v[128:131], v[64:67], a[128:131], v[128:131]
    buffer_load_dwordx4 v16, s[24:27], s6 offen lds
    v_mfma_f32_16x16x32_bf16 v[132:135], v[64:67], a[132:135], v[132:135]
    v_mfma_f32_16x16x32_bf16 v[136:139], v[64:67], a[136:139], v[136:139]
    ds_read_b128 a[144:147], v39 offset:12288
    buffer_load_dwordx4 v17, s[24:27], s6 offen offset:1024 lds
    v_mfma_f32_16x16x32_bf16 v[140:143], v[64:67], a[140:143], v[140:143]
    v_mfma_f32_16x16x32_bf16 v[144:147], v[68:71], a[128:131], v[144:147]
    ds_read_b128 a[148:151], v39 offset:13312
    buffer_load_dwordx4 v18, s[24:27], s6 offen offset:2048 lds
    v_mfma_f32_16x16x32_bf16 v[148:151], v[68:71], a[132:135], v[148:151]
    v_mfma_f32_16x16x32_bf16 v[152:155], v[68:71], a[136:139], v[152:155]
    ds_read_b128 a[152:155], v39 offset:14336
    buffer_load_dwordx4 v19, s[24:27], s6 offen offset:3072 lds
    v_mfma_f32_16x16x32_bf16 v[156:159], v[68:71], a[140:143], v[156:159]
    v_mfma_f32_16x16x32_bf16 v[160:163], v[72:75], a[128:131], v[160:163]
    ds_read_b128 a[156:159], v39 offset:15360
    s_add_u32 m0, s5, 12288
    s_add_u32 s6, s93, 14336
    v_mfma_f32_16x16x32_bf16 v[164:167], v[72:75], a[132:135], v[164:167]
    buffer_load_dwordx4 v16, s[24:27], s6 offen lds
    v_mfma_f32_16x16x32_bf16 v[168:171], v[72:75], a[136:139], v[168:171]
    v_mfma_f32_16x16x32_bf16 v[172:175], v[72:75], a[140:143], v[172:175]
    buffer_load_dwordx4 v17, s[24:27], s6 offen offset:1024 lds
    v_mfma_f32_16x16x32_bf16 v[176:179], v[76:79], a[128:131], v[176:179]
    v_mfma_f32_16x16x32_bf16 v[180:183], v[76:79], a[132:135], v[180:183]
    buffer_load_dwordx4 v18, s[24:27], s6 offen offset:2048 lds
    v_mfma_f32_16x16x32_bf16 v[184:187], v[76:79], a[136:139], v[184:187]
    s_waitcnt vmcnt(15)
    ds_read_b64_tr_b16 v[96:97], v32 offset:16384
    ds_read_b64_tr_b16 v[98:99], v32 offset:17408
    v_mfma_f32_16x16x32_bf16 v[188:191], v[76:79], a[140:143], v[188:191]
    buffer_load_dwordx4 v19, s[24:27], s6 offen offset:3072 lds
    ds_read_b64_tr_b16 v[100:101], v33 offset:16384
    v_mfma_f32_16x16x32_bf16 v[192:195], v[80:83], a[128:131], v[192:195]
    ds_read_b64_tr_b16 v[102:103], v33 offset:17408
    ds_read_b64_tr_b16 v[104:105], v34 offset:16384
    v_mfma_f32_16x16x32_bf16 v[196:199], v[80:83], a[132:135], v[196:199]
    ds_read_b64_tr_b16 v[106:107], v34 offset:17408
    ds_read_b64_tr_b16 v[108:109], v35 offset:16384
    v_mfma_f32_16x16x32_bf16 v[200:203], v[80:83], a[136:139], v[200:203]
    ds_read_b64_tr_b16 v[110:111], v35 offset:17408
    ds_read_b64_tr_b16 v[112:113], v36 offset:16384
    v_mfma_f32_16x16x32_bf16 v[204:207], v[80:83], a[140:143], v[204:207]
    ds_read_b64_tr_b16 v[114:115], v36 offset:17408
    ds_read_b64_tr_b16 v[116:117], v37 offset:16384
    v_mfma_f32_16x16x32_bf16 v[208:211], v[84:87], a[128:131], v[208:211]
    s_waitcnt lgkmcnt(14)
    ds_read_b64_tr_b16 v[118:119], v37 offset:17408
    s_waitcnt lgkmcnt(14)
    ds_read_b64_tr_b16 v[120:121], v38 offset:16384
    v_mfma_f32_16x16x32_bf16 v[212:215], v[84:87], a[132:135], v[212:215]
    s_waitcnt lgkmcnt(14)
    ds_read_b64_tr_b16 v[122:123], v38 offset:17408
    v_mfma_f32_16x16x32_bf16 v[216:219], v[84:87], a[136:139], v[216:219]
    v_mfma_f32_16x16x32_bf16 v[220:223], v[84:87], a[140:143], v[220:223]
    v_mfma_f32_16x16x32_bf16 v[224:227], v[88:91], a[128:131], v[224:227]
    v_mfma_f32_16x16x32_bf16 v[228:231], v[88:91], a[132:135], v[228:231]
    v_mfma_f32_16x16x32_bf16 v[232:235], v[88:91], a[136:139], v[232:235]
    v_mfma_f32_16x16x32_bf16 v[236:239], v[88:91], a[140:143], v[236:239]
    s_waitcnt lgkmcnt(12)
    v_mfma_f32_16x16x32_bf16 v[128:131], v[96:99], a[144:147], v[128:131]
    s_waitcnt lgkmcnt(0)
    s_add_u32 m0, s5, 16384
    s_add_u32 s6, s94, 0
    v_mfma_f32_16x16x32_bf16 v[132:135], v[96:99], a[148:151], v[132:135]
    buffer_load_dwordx4 v16, s[24:27], s6 offen lds
    v_mfma_f32_16x16x32_bf16 v[136:139], v[96:99], a[152:155], v[136:139]
    ds_read_b128 a[128:131], v39 offset:16384
    v_mfma_f32_16x16x32_bf16 v[140:143], v[96:99], a[156:159], v[140:143]
    buffer_load_dwordx4 v17, s[24:27], s6 offen offset:1024 lds
    v_mfma_f32_16x16x32_bf16 v[144:147], v[100:103], a[144:147], v[144:147]
    ds_read_b128 a[132:135], v39 offset:17408
    v_mfma_f32_16x16x32_bf16 v[148:151], v[100:103], a[148:151], v[148:151]
    buffer_load_dwordx4 v18, s[24:27], s6 offen offset:2048 lds
    v_mfma_f32_16x16x32_bf16 v[152:155], v[100:103], a[152:155], v[152:155]
    ds_read_b128 a[136:139], v39 offset:18432
    v_mfma_f32_16x16x32_bf16 v[156:159], v[100:103], a[156:159], v[156:159]
    buffer_load_dwordx4 v19, s[24:27], s6 offen offset:3072 lds
    v_mfma_f32_16x16x32_bf16 v[160:163], v[104:107], a[144:147], v[160:163]
    ds_read_b128 a[140:143], v39 offset:19456
    v_mfma_f32_16x16x32_bf16 v[164:167], v[104:107], a[148:151], v[164:167]
    s_add_u32 m0, s5, 20480
    s_add_u32 s6, s94, 14336
    v_mfma_f32_16x16x32_bf16 v[168:171], v[104:107], a[152:155], v[168:171]
    buffer_load_dwordx4 v16, s[24:27], s6 offen lds
    v_mfma_f32_16x16x32_bf16 v[172:175], v[104:107], a[156:159], v[172:175]
    v_mfma_f32_16x16x32_bf16 v[176:179], v[108:111], a[144:147], v[176:179]
    buffer_load_dwordx4 v17, s[24:27], s6 offen offset:1024 lds
    v_mfma_f32_16x16x32_bf16 v[180:183], v[108:111], a[148:151], v[180:183]
    v_mfma_f32_16x16x32_bf16 v[184:187], v[108:111], a[152:155], v[184:187]
    buffer_load_dwordx4 v18, s[24:27], s6 offen offset:2048 lds
    s_waitcnt vmcnt(15)
    ds_read_b64_tr_b16 v[64:65], v32 offset:0
    v_mfma_f32_16x16x32_bf16 v[188:191], v[108:111], a[156:159], v[188:191]
    buffer_load_dwordx4 v19, s[24:27], s6 offen offset:3072 lds
    ds_read_b64_tr_b16 v[66:67], v32 offset:1024
    v_mfma_f32_16x16x32_bf16 v[192:195], v[112:115], a[144:147], v[192:195]
    ds_read_b64_tr_b16 v[68:69], v33 offset:0
    ds_read_b64_tr_b16 v[70:71], v33 offset:1024
    v_mfma_f32_16x16x32_bf16 v[196:199], v[112:115], a[148:151], v[196:199]
    ds_read_b64_tr_b16 v[72:73], v34 offset:0
    ds_read_b64_tr_b16 v[74:75], v34 offset:1024
    v_mfma_f32_16x16x32_bf16 v[200:203], v[112:115], a[152:155], v[200:203]
    ds_read_b64_tr_b16 v[76:77], v35 offset:0
    ds_read_b64_tr_b16 v[78:79], v35 offset:1024
    v_mfma_f32_16x16x32_bf16 v[204:207], v[112:115], a[156:159], v[204:207]
    ds_read_b64_tr_b16 v[80:81], v36 offset:0
    ds_read_b64_tr_b16 v[82:83], v36 offset:1024
    v_mfma_f32_16x16x32_bf16 v[208:211], v[116:119], a[144:147], v[208:211]
    ds_read_b64_tr_b16 v[84:85], v37 offset:0
    s_waitcnt lgkmcnt(14)
    ds_read_b64_tr_b16 v[86:87], v37 offset:1024
    v_mfma_f32_16x16x32_bf16 v[212:215], v[116:119], a[148:151], v[212:215]
    s_waitcnt lgkmcnt(14)
    ds_read_b64_tr_b16 v[88:89], v38 offset:0
    s_waitcnt lgkmcnt(14)
    ds_read_b64_tr_b16 v[90:91], v38 offset:1024
    v_mfma_f32_16x16x32_bf16 v[216:219], v[116:119], a[152:155], v[216:219]
    v_mfma_f32_16x16x32_bf16 v[220:223], v[116:119], a[156:159], v[220:223]
    v_mfma_f32_16x16x32_bf16 v[224:227], v[120:123], a[144:147], v[224:227]
    v_mfma_f32_16x16x32_bf16 v[228:231], v[120:123], a[148:151], v[228:231]
    v_mfma_f32_16x16x32_bf16 v[232:235], v[120:123], a[152:155], v[232:235]
    v_mfma_f32_16x16x32_bf16 v[236:239], v[120:123], a[156:159], v[236:239]
    s_waitcnt lgkmcnt(12)
    v_mfma_f32_16x16x32_bf16 v[128:131], v[64:67], a[128:131], v[128:131]
    s_waitcnt lgkmcnt(0)
    s_add_u32 m0, s5, 0
    s_add_u32 s6, s95, 0
    v_mfma_f32_16x16x32_bf16 v[132:135], v[64:67], a[132:135], v[132:135]
    buffer_load_dwordx4 v16, s[24:27], s6 offen lds
    v_mfma_f32_16x16x32_bf16 v[136:139], v[64:67], a[136:139], v[136:139]
    ds_read_b128 a[144:147], v39 offset:20480
    v_mfma_f32_16x16x32_bf16 v[140:143], v[64:67], a[140:143], v[140:143]
    buffer_load_dwordx4 v17, s[24:27], s6 offen offset:1024 lds
    v_mfma_f32_16x16x32_bf16 v[144:147], v[68:71], a[128:131], v[144:147]
    ds_read_b128 a[148:151], v39 offset:21504
    v_mfma_f32_16x16x32_bf16 v[148:151], v[68:71], a[132:135], v[148:151]
    buffer_load_dwordx4 v18, s[24:27], s6 offen offset:2048 lds
    v_mfma_f32_16x16x32_bf16 v[152:155], v[68:71], a[136:139], v[152:155]
    ds_read_b128 a[152:155], v39 offset:22528
    v_mfma_f32_16x16x32_bf16 v[156:159], v[68:71], a[140:143], v[156:159]
    buffer_load_dwordx4 v19, s[24:27], s6 offen offset:3072 lds
    v_mfma_f32_16x16x32_bf16 v[160:163], v[72:75], a[128:131], v[160:163]
    ds_read_b128 a[156:159], v39 offset:23552
    v_mfma_f32_16x16x32_bf16 v[164:167], v[72:75], a[132:135], v[164:167]
    s_add_u32 m0, s5, 4096
    s_add_u32 s6, s95, 14336
    v_mfma_f32_16x16x32_bf16 v[168:171], v[72:75], a[136:139], v[168:171]
    buffer_load_dwordx4 v16, s[24:27], s6 offen lds
    v_mfma_f32_16x16x32_bf16 v[172:175], v[72:75], a[140:143], v[172:175]
    v_mfma_f32_16x16x32_bf16 v[176:179], v[76:79], a[128:131], v[176:179]
    buffer_load_dwordx4 v17, s[24:27], s6 offen offset:1024 lds
    v_mfma_f32_16x16x32_bf16 v[180:183], v[76:79], a[132:135], v[180:183]
    v_mfma_f32_16x16x32_bf16 v[184:187], v[76:79], a[136:139], v[184:187]
    buffer_load_dwordx4 v18, s[24:27], s6 offen offset:2048 lds
    s_waitcnt vmcnt(15)
    ds_read_b64_tr_b16 v[96:97], v32 offset:8192
    v_mfma_f32_16x16x32_bf16 v[188:191], v[76:79], a[140:143], v[188:191]
    buffer_load_dwordx4 v19, s[24:27], s6 offen offset:3072 lds
    ds_read_b64_tr_b16 v[98:99], v32 offset:9216
    v_mfma_f32_16x16x32_bf16 v[192:195], v[80:83], a[128:131], v[192:195]
    ds_read_b64_tr_b16 v[100:101], v33 offset:8192
    ds_read_b64_tr_b16 v[102:103], v33 offset:9216
    v_mfma_f32_16x16x32_bf16 v[196:199], v[80:83], a[132:135], v[196:199]
    ds_read_b64_tr_b16 v[104:105], v34 offset:8192
    ds_read_b64_tr_b16 v[106:107], v34 offset:9216
    v_mfma_f32_16x16x32_bf16 v[200:203], v[80:83], a[136:139], v[200:203]
    ds_read_b64_tr_b16 v[108:109], v35 offset:8192
    ds_read_b64_tr_b16 v[110:111], v35 offset:9216
    v_mfma_f32_16x16x32_bf16 v[204:207], v[80:83], a[140:143], v[204:207]
    ds_read_b64_tr_b16 v[112:113], v36 offset:8192
    ds_read_b64_tr_b16 v[114:115], v36 offset:9216
    v_mfma_f32_16x16x32_bf16 v[208:211], v[84:87], a[128:131], v[208:211]
    ds_read_b64_tr_b16 v[116:117], v37 offset:8192
    s_waitcnt lgkmcnt(14)
    ds_read_b64_tr_b16 v[118:119], v37 offset:9216
    v_mfma_f32_16x16x32_bf16 v[212:215], v[84:87], a[132:135], v[212:215]
    s_waitcnt lgkmcnt(14)
    ds_read_b64_tr_b16 v[120:121], v38 offset:8192
    s_waitcnt lgkmcnt(14)
    ds_read_b64_tr_b16 v[122:123], v38 offset:9216
    v_mfma_f32_16x16x32_bf16 v[216:219], v[84:87], a[136:139], v[216:219]
    v_mfma_f32_16x16x32_bf16 v[220:223], v[84:87], a[140:143], v[220:223]
    v_mfma_f32_16x16x32_bf16 v[224:227], v[88:91], a[128:131], v[224:227]
    v_mfma_f32_16x16x32_bf16 v[228:231], v[88:91], a[132:135], v[228:231]
    v_mfma_f32_16x16x32_bf16 v[232:235], v[88:91], a[136:139], v[232:235]
    v_mfma_f32_16x16x32_bf16 v[236:239], v[88:91], a[140:143], v[236:239]
    s_waitcnt lgkmcnt(12)
    v_mfma_f32_16x16x32_bf16 v[128:131], v[96:99], a[144:147], v[128:131]
    v_mfma_f32_16x16x32_bf16 v[132:135], v[96:99], a[148:151], v[132:135]
    v_mfma_f32_16x16x32_bf16 v[136:139], v[96:99], a[152:155], v[136:139]
    ds_read_b128 a[128:131], v39 offset:24576
    v_mfma_f32_16x16x32_bf16 v[140:143], v[96:99], a[156:159], v[140:143]
    s_waitcnt lgkmcnt(11)
    v_mfma_f32_16x16x32_bf16 v[144:147], v[100:103], a[144:147], v[144:147]
    ds_read_b128 a[132:135], v39 offset:25600
    v_mfma_f32_16x16x32_bf16 v[148:151], v[100:103], a[148:151], v[148:151]
    v_mfma_f32_16x16x32_bf16 v[152:155], v[100:103], a[152:155], v[152:155]
    ds_read_b128 a[136:139], v39 offset:26624
    v_mfma_f32_16x16x32_bf16 v[156:159], v[100:103], a[156:159], v[156:159]
    s_waitcnt lgkmcnt(11)
    v_mfma_f32_16x16x32_bf16 v[160:163], v[104:107], a[144:147], v[160:163]
    ds_read_b128 a[140:143], v39 offset:27648
    v_mfma_f32_16x16x32_bf16 v[164:167], v[104:107], a[148:151], v[164:167]
    v_mfma_f32_16x16x32_bf16 v[168:171], v[104:107], a[152:155], v[168:171]
    v_mfma_f32_16x16x32_bf16 v[172:175], v[104:107], a[156:159], v[172:175]
    s_waitcnt lgkmcnt(10)
    v_mfma_f32_16x16x32_bf16 v[176:179], v[108:111], a[144:147], v[176:179]
    v_mfma_f32_16x16x32_bf16 v[180:183], v[108:111], a[148:151], v[180:183]
    v_mfma_f32_16x16x32_bf16 v[184:187], v[108:111], a[152:155], v[184:187]
    s_waitcnt vmcnt(8)
    ds_read_b64_tr_b16 v[64:65], v32 offset:16384
    ds_read_b64_tr_b16 v[66:67], v32 offset:17408
    v_mfma_f32_16x16x32_bf16 v[188:191], v[108:111], a[156:159], v[188:191]
    ds_read_b64_tr_b16 v[68:69], v33 offset:16384
    ds_read_b64_tr_b16 v[70:71], v33 offset:17408
    s_waitcnt lgkmcnt(12)
    v_mfma_f32_16x16x32_bf16 v[192:195], v[112:115], a[144:147], v[192:195]
    ds_read_b64_tr_b16 v[72:73], v34 offset:16384
    ds_read_b64_tr_b16 v[74:75], v34 offset:17408
    v_mfma_f32_16x16x32_bf16 v[196:199], v[112:115], a[148:151], v[196:199]
    ds_read_b64_tr_b16 v[76:77], v35 offset:16384
    s_waitcnt lgkmcnt(14)
    ds_read_b64_tr_b16 v[78:79], v35 offset:17408
    v_mfma_f32_16x16x32_bf16 v[200:203], v[112:115], a[152:155], v[200:203]
    s_waitcnt lgkmcnt(14)
    ds_read_b64_tr_b16 v[80:81], v36 offset:16384
    s_waitcnt lgkmcnt(14)
    ds_read_b64_tr_b16 v[82:83], v36 offset:17408
    v_mfma_f32_16x16x32_bf16 v[204:207], v[112:115], a[156:159], v[204:207]
    s_waitcnt lgkmcnt(14)
    ds_read_b64_tr_b16 v[84:85], v37 offset:16384
    s_waitcnt lgkmcnt(14)
    ds_read_b64_tr_b16 v[86:87], v37 offset:17408
    v_mfma_f32_16x16x32_bf16 v[208:211], v[116:119], a[144:147], v[208:211]
    s_waitcnt lgkmcnt(14)
    ds_read_b64_tr_b16 v[88:89], v38 offset:16384
    s_waitcnt lgkmcnt(14)
    ds_read_b64_tr_b16 v[90:91], v38 offset:17408
    v_mfma_f32_16x16x32_bf16 v[212:215], v[116:119], a[148:151], v[212:215]
    v_mfma_f32_16x16x32_bf16 v[216:219], v[116:119], a[152:155], v[216:219]
    v_mfma_f32_16x16x32_bf16 v[220:223], v[116:119], a[156:159], v[220:223]
    v_mfma_f32_16x16x32_bf16 v[224:227], v[120:123], a[144:147], v[224:227]
    v_mfma_f32_16x16x32_bf16 v[228:231], v[120:123], a[148:151], v[228:231]
    v_mfma_f32_16x16x32_bf16 v[232:235], v[120:123], a[152:155], v[232:235]
    v_mfma_f32_16x16x32_bf16 v[236:239], v[120:123], a[156:159], v[236:239]
    s_waitcnt lgkmcnt(12)
    v_mfma_f32_16x16x32_bf16 v[128:131], v[64:67], a[128:131], v[128:131]
    v_mfma_f32_16x16x32_bf16 v[132:135], v[64:67], a[132:135], v[132:135]
    v_mfma_f32_16x16x32_bf16 v[136:139], v[64:67], a[136:139], v[136:139]
    ds_read_b128 a[144:147], v39 offset:28672
    v_mfma_f32_16x16x32_bf16 v[140:143], v[64:67], a[140:143], v[140:143]
    s_waitcnt lgkmcnt(11)
    v_mfma_f32_16x16x32_bf16 v[144:147], v[68:71], a[128:131], v[144:147]
    ds_read_b128 a[148:151], v39 offset:29696
    v_mfma_f32_16x16x32_bf16 v[148:151], v[68:71], a[132:135], v[148:151]
    v_mfma_f32_16x16x32_bf16 v[152:155], v[68:71], a[136:139], v[152:155]
    ds_read_b128 a[152:155], v39 offset:30720
    v_mfma_f32_16x16x32_bf16 v[156:159], v[68:71], a[140:143], v[156:159]
    s_waitcnt lgkmcnt(11)
    v_mfma_f32_16x16x32_bf16 v[160:163], v[72:75], a[128:131], v[160:163]
    ds_read_b128 a[156:159], v39 offset:31744
    v_mfma_f32_16x16x32_bf16 v[164:167], v[72:75], a[132:135], v[164:167]
    v_mfma_f32_16x16x32_bf16 v[168:171], v[72:75], a[136:139], v[168:171]
    v_mfma_f32_16x16x32_bf16 v[172:175], v[72:75], a[140:143], v[172:175]
    s_waitcnt lgkmcnt(10)
    v_mfma_f32_16x16x32_bf16 v[176:179], v[76:79], a[128:131], v[176:179]
    v_mfma_f32_16x16x32_bf16 v[180:183], v[76:79], a[132:135], v[180:183]
    v_mfma_f32_16x16x32_bf16 v[184:187], v[76:79], a[136:139], v[184:187]
    s_waitcnt vmcnt(0)
    ds_read_b64_tr_b16 v[96:97], v32 offset:0
    ds_read_b64_tr_b16 v[98:99], v32 offset:1024
    v_mfma_f32_16x16x32_bf16 v[188:191], v[76:79], a[140:143], v[188:191]
    ds_read_b64_tr_b16 v[100:101], v33 offset:0
    ds_read_b64_tr_b16 v[102:103], v33 offset:1024
    s_waitcnt lgkmcnt(12)
    v_mfma_f32_16x16x32_bf16 v[192:195], v[80:83], a[128:131], v[192:195]
    ds_read_b64_tr_b16 v[104:105], v34 offset:0
    ds_read_b64_tr_b16 v[106:107], v34 offset:1024
    v_mfma_f32_16x16x32_bf16 v[196:199], v[80:83], a[132:135], v[196:199]
    ds_read_b64_tr_b16 v[108:109], v35 offset:0
    s_waitcnt lgkmcnt(14)
    ds_read_b64_tr_b16 v[110:111], v35 offset:1024
    v_mfma_f32_16x16x32_bf16 v[200:203], v[80:83], a[136:139], v[200:203]
    s_waitcnt lgkmcnt(14)
    ds_read_b64_tr_b16 v[112:113], v36 offset:0
    s_waitcnt lgkmcnt(14)
    ds_read_b64_tr_b16 v[114:115], v36 offset:1024
    v_mfma_f32_16x16x32_bf16 v[204:207], v[80:83], a[140:143], v[204:207]
    s_waitcnt lgkmcnt(14)
    ds_read_b64_tr_b16 v[116:117], v37 offset:0
    s_waitcnt lgkmcnt(14)
    ds_read_b64_tr_b16 v[118:119], v37 offset:1024
    v_mfma_f32_16x16x32_bf16 v[208:211], v[84:87], a[128:131], v[208:211]
    s_waitcnt lgkmcnt(14)
    ds_read_b64_tr_b16 v[120:121], v38 offset:0
    s_waitcnt lgkmcnt(14)
    ds_read_b64_tr_b16 v[122:123], v38 offset:1024
    v_mfma_f32_16x16x32_bf16 v[212:215], v[84:87], a[132:135], v[212:215]
    v_mfma_f32_16x16x32_bf16 v[216:219], v[84:87], a[136:139], v[216:219]
    v_mfma_f32_16x16x32_bf16 v[220:223], v[84:87], a[140:143], v[220:223]
    v_mfma_f32_16x16x32_bf16 v[224:227], v[88:91], a[128:131], v[224:227]
    v_mfma_f32_16x16x32_bf16 v[228:231], v[88:91], a[132:135], v[228:231]
    v_mfma_f32_16x16x32_bf16 v[232:235], v[88:91], a[136:139], v[232:235]
    v_mfma_f32_16x16x32_bf16 v[236:239], v[88:91], a[140:143], v[236:239]
    s_waitcnt lgkmcnt(12)
    v_mfma_f32_16x16x32_bf16 v[128:131], v[96:99], a[144:147], v[128:131]
    v_mfma_f32_16x16x32_bf16 v[132:135], v[96:99], a[148:151], v[132:135]
    v_mfma_f32_16x16x32_bf16 v[136:139], v[96:99], a[152:155], v[136:139]
    v_mfma_f32_16x16x32_bf16 v[140:143], v[96:99], a[156:159], v[140:143]
    s_waitcnt lgkmcnt(10)
    v_mfma_f32_16x16x32_bf16 v[144:147], v[100:103], a[144:147], v[144:147]
    v_mfma_f32_16x16x32_bf16 v[148:151], v[100:103], a[148:151], v[148:151]
    v_mfma_f32_16x16x32_bf16 v[152:155], v[100:103], a[152:155], v[152:155]
    v_mfma_f32_16x16x32_bf16 v[156:159], v[100:103], a[156:159], v[156:159]
    s_waitcnt lgkmcnt(8)
    v_mfma_f32_16x16x32_bf16 v[160:163], v[104:107], a[144:147], v[160:163]
    v_pk_mul_f32 v[128:129], v[128:129], v[48:49] op_sel:[0,0] op_sel_hi:[1,0]
    v_pk_mul_f32 v[130:131], v[130:131], v[48:49] op_sel:[0,0] op_sel_hi:[1,0]
    v_pk_mul_f32 v[132:133], v[132:133], v[52:53] op_sel:[0,0] op_sel_hi:[1,0]
    v_pk_mul_f32 v[134:135], v[134:135], v[52:53] op_sel:[0,0] op_sel_hi:[1,0]
    v_cvt_pk_bf16_f32 v128, v128, v129
    v_mfma_f32_16x16x32_bf16 v[164:167], v[104:107], a[148:151], v[164:167]
    v_cvt_pk_bf16_f32 v129, v130, v131
    v_cvt_pk_bf16_f32 v130, v132, v133
    v_cvt_pk_bf16_f32 v131, v134, v135
    buffer_store_dwordx4 v[128:131], v47, s[28:31], s68 offen offset:0 sc1
    v_pk_mul_f32 v[136:137], v[136:137], v[56:57] op_sel:[0,0] op_sel_hi:[1,0]
    v_mfma_f32_16x16x32_bf16 v[168:171], v[104:107], a[152:155], v[168:171]
    v_pk_mul_f32 v[138:139], v[138:139], v[56:57] op_sel:[0,0] op_sel_hi:[1,0]
    v_pk_mul_f32 v[140:141], v[140:141], v[60:61] op_sel:[0,0] op_sel_hi:[1,0]
    v_pk_mul_f32 v[142:143], v[142:143], v[60:61] op_sel:[0,0] op_sel_hi:[1,0]
    v_cvt_pk_bf16_f32 v136, v136, v137
    v_cvt_pk_bf16_f32 v137, v138, v139
    v_mfma_f32_16x16x32_bf16 v[172:175], v[104:107], a[156:159], v[172:175]
    v_cvt_pk_bf16_f32 v138, v140, v141
    v_cvt_pk_bf16_f32 v139, v142, v143
    buffer_store_dwordx4 v[136:139], v47, s[28:31], s68 offen offset:1024 sc1
    s_waitcnt lgkmcnt(6)
    v_mfma_f32_16x16x32_bf16 v[176:179], v[108:111], a[144:147], v[176:179]
    v_pk_mul_f32 v[144:145], v[144:145], v[48:49] op_sel:[0,0] op_sel_hi:[1,0]
    v_pk_mul_f32 v[146:147], v[146:147], v[48:49] op_sel:[0,0] op_sel_hi:[1,0]
    v_pk_mul_f32 v[148:149], v[148:149], v[52:53] op_sel:[0,0] op_sel_hi:[1,0]
    v_pk_mul_f32 v[150:151], v[150:151], v[52:53] op_sel:[0,0] op_sel_hi:[1,0]
    v_cvt_pk_bf16_f32 v144, v144, v145
    v_mfma_f32_16x16x32_bf16 v[180:183], v[108:111], a[148:151], v[180:183]
    v_cvt_pk_bf16_f32 v145, v146, v147
    v_cvt_pk_bf16_f32 v146, v148, v149
    v_cvt_pk_bf16_f32 v147, v150, v151
    buffer_store_dwordx4 v[144:147], v47, s[28:31], s68 offen offset:2048 sc1
    v_pk_mul_f32 v[152:153], v[152:153], v[56:57] op_sel:[0,0] op_sel_hi:[1,0]
    v_mfma_f32_16x16x32_bf16 v[184:187], v[108:111], a[152:155], v[184:187]
    v_pk_mul_f32 v[154:155], v[154:155], v[56:57] op_sel:[0,0] op_sel_hi:[1,0]
    v_pk_mul_f32 v[156:157], v[156:157], v[60:61] op_sel:[0,0] op_sel_hi:[1,0]
    v_pk_mul_f32 v[158:159], v[158:159], v[60:61] op_sel:[0,0] op_sel_hi:[1,0]
    v_cvt_pk_bf16_f32 v152, v152, v153
    v_cvt_pk_bf16_f32 v153, v154, v155
    v_mfma_f32_16x16x32_bf16 v[188:191], v[108:111], a[156:159], v[188:191]
    v_cvt_pk_bf16_f32 v154, v156, v157
    v_cvt_pk_bf16_f32 v155, v158, v159
    buffer_store_dwordx4 v[152:155], v47, s[28:31], s68 offen offset:3072 sc1
    s_waitcnt lgkmcnt(4)
    v_mfma_f32_16x16x32_bf16 v[192:195], v[112:115], a[144:147], v[192:195]
    v_pk_mul_f32 v[160:161], v[160:161], v[48:49] op_sel:[0,0] op_sel_hi:[1,0]
    v_pk_mul_f32 v[162:163], v[162:163], v[48:49] op_sel:[0,0] op_sel_hi:[1,0]
    v_pk_mul_f32 v[164:165], v[164:165], v[52:53] op_sel:[0,0] op_sel_hi:[1,0]
    v_pk_mul_f32 v[166:167], v[166:167], v[52:53] op_sel:[0,0] op_sel_hi:[1,0]
    v_cvt_pk_bf16_f32 v160, v160, v161
    v_mfma_f32_16x16x32_bf16 v[196:199], v[112:115], a[148:151], v[196:199]
    v_cvt_pk_bf16_f32 v161, v162, v163
    v_cvt_pk_bf16_f32 v162, v164, v165
    v_cvt_pk_bf16_f32 v163, v166, v167
    buffer_store_dwordx4 v[160:163], v47, s[28:31], s69 offen offset:0 sc1
    v_pk_mul_f32 v[168:169], v[168:169], v[56:57] op_sel:[0,0] op_sel_hi:[1,0]
    v_mfma_f32_16x16x32_bf16 v[200:203], v[112:115], a[152:155], v[200:203]
    v_pk_mul_f32 v[170:171], v[170:171], v[56:57] op_sel:[0,0] op_sel_hi:[1,0]
    v_pk_mul_f32 v[172:173], v[172:173], v[60:61] op_sel:[0,0] op_sel_hi:[1,0]
    v_pk_mul_f32 v[174:175], v[174:175], v[60:61] op_sel:[0,0] op_sel_hi:[1,0]
    v_cvt_pk_bf16_f32 v168, v168, v169
    v_cvt_pk_bf16_f32 v169, v170, v171
    v_mfma_f32_16x16x32_bf16 v[204:207], v[112:115], a[156:159], v[204:207]
    v_cvt_pk_bf16_f32 v170, v172, v173
    v_cvt_pk_bf16_f32 v171, v174, v175
    buffer_store_dwordx4 v[168:171], v47, s[28:31], s69 offen offset:1024 sc1
    s_waitcnt lgkmcnt(2)
    v_mfma_f32_16x16x32_bf16 v[208:211], v[116:119], a[144:147], v[208:211]
    v_pk_mul_f32 v[176:177], v[176:177], v[48:49] op_sel:[0,0] op_sel_hi:[1,0]
    v_pk_mul_f32 v[178:179], v[178:179], v[48:49] op_sel:[0,0] op_sel_hi:[1,0]
    v_pk_mul_f32 v[180:181], v[180:181], v[52:53] op_sel:[0,0] op_sel_hi:[1,0]
    v_pk_mul_f32 v[182:183], v[182:183], v[52:53] op_sel:[0,0] op_sel_hi:[1,0]
    v_cvt_pk_bf16_f32 v176, v176, v177
    v_mfma_f32_16x16x32_bf16 v[212:215], v[116:119], a[148:151], v[212:215]
    v_cvt_pk_bf16_f32 v177, v178, v179
    v_cvt_pk_bf16_f32 v178, v180, v181
    v_cvt_pk_bf16_f32 v179, v182, v183
    buffer_store_dwordx4 v[176:179], v47, s[28:31], s69 offen offset:2048 sc1
    v_pk_mul_f32 v[184:185], v[184:185], v[56:57] op_sel:[0,0] op_sel_hi:[1,0]
    v_mfma_f32_16x16x32_bf16 v[216:219], v[116:119], a[152:155], v[216:219]
    v_pk_mul_f32 v[186:187], v[186:187], v[56:57] op_sel:[0,0] op_sel_hi:[1,0]
    v_pk_mul_f32 v[188:189], v[188:189], v[60:61] op_sel:[0,0] op_sel_hi:[1,0]
    v_pk_mul_f32 v[190:191], v[190:191], v[60:61] op_sel:[0,0] op_sel_hi:[1,0]
    v_cvt_pk_bf16_f32 v184, v184, v185
    v_cvt_pk_bf16_f32 v185, v186, v187
    v_mfma_f32_16x16x32_bf16 v[220:223], v[116:119], a[156:159], v[220:223]
    v_cvt_pk_bf16_f32 v186, v188, v189
    v_cvt_pk_bf16_f32 v187, v190, v191
    buffer_store_dwordx4 v[184:187], v47, s[28:31], s69 offen offset:3072 sc1
    s_waitcnt lgkmcnt(0)
    v_mfma_f32_16x16x32_bf16 v[224:227], v[120:123], a[144:147], v[224:227]
    v_pk_mul_f32 v[192:193], v[192:193], v[48:49] op_sel:[0,0] op_sel_hi:[1,0]
    v_pk_mul_f32 v[194:195], v[194:195], v[48:49] op_sel:[0,0] op_sel_hi:[1,0]
    v_pk_mul_f32 v[196:197], v[196:197], v[52:53] op_sel:[0,0] op_sel_hi:[1,0]
    v_pk_mul_f32 v[198:199], v[198:199], v[52:53] op_sel:[0,0] op_sel_hi:[1,0]
    v_cvt_pk_bf16_f32 v192, v192, v193
    v_mfma_f32_16x16x32_bf16 v[228:231], v[120:123], a[148:151], v[228:231]
    v_cvt_pk_bf16_f32 v193, v194, v195
    v_cvt_pk_bf16_f32 v194, v196, v197
    v_cvt_pk_bf16_f32 v195, v198, v199
    buffer_store_dwordx4 v[192:195], v47, s[28:31], s70 offen offset:0 sc1
    v_pk_mul_f32 v[200:201], v[200:201], v[56:57] op_sel:[0,0] op_sel_hi:[1,0]
    v_mfma_f32_16x16x32_bf16 v[232:235], v[120:123], a[152:155], v[232:235]
    v_pk_mul_f32 v[202:203], v[202:203], v[56:57] op_sel:[0,0] op_sel_hi:[1,0]
    v_pk_mul_f32 v[204:205], v[204:205], v[60:61] op_sel:[0,0] op_sel_hi:[1,0]
    v_pk_mul_f32 v[206:207], v[206:207], v[60:61] op_sel:[0,0] op_sel_hi:[1,0]
    v_cvt_pk_bf16_f32 v200, v200, v201
    v_cvt_pk_bf16_f32 v201, v202, v203
    v_mfma_f32_16x16x32_bf16 v[236:239], v[120:123], a[156:159], v[236:239]
    v_cvt_pk_bf16_f32 v202, v204, v205
    v_cvt_pk_bf16_f32 v203, v206, v207
    buffer_store_dwordx4 v[200:203], v47, s[28:31], s70 offen offset:1024 sc1
    v_pk_mul_f32 v[208:209], v[208:209], v[48:49] op_sel:[0,0] op_sel_hi:[1,0]
    v_pk_mul_f32 v[210:211], v[210:211], v[48:49] op_sel:[0,0] op_sel_hi:[1,0]
    v_pk_mul_f32 v[212:213], v[212:213], v[52:53] op_sel:[0,0] op_sel_hi:[1,0]
    v_pk_mul_f32 v[214:215], v[214:215], v[52:53] op_sel:[0,0] op_sel_hi:[1,0]
    v_cvt_pk_bf16_f32 v208, v208, v209
    v_cvt_pk_bf16_f32 v209, v210, v211
    v_cvt_pk_bf16_f32 v210, v212, v213
    v_cvt_pk_bf16_f32 v211, v214, v215
    buffer_store_dwordx4 v[208:211], v47, s[28:31], s70 offen offset:2048 sc1
    v_pk_mul_f32 v[216:217], v[216:217], v[56:57] op_sel:[0,0] op_sel_hi:[1,0]
    v_pk_mul_f32 v[218:219], v[218:219], v[56:57] op_sel:[0,0] op_sel_hi:[1,0]
    v_pk_mul_f32 v[220:221], v[220:221], v[60:61] op_sel:[0,0] op_sel_hi:[1,0]
    v_pk_mul_f32 v[222:223], v[222:223], v[60:61] op_sel:[0,0] op_sel_hi:[1,0]
    v_cvt_pk_bf16_f32 v216, v216, v217
    v_cvt_pk_bf16_f32 v217, v218, v219
    v_cvt_pk_bf16_f32 v218, v220, v221
    v_cvt_pk_bf16_f32 v219, v222, v223
    buffer_store_dwordx4 v[216:219], v47, s[28:31], s70 offen offset:3072 sc1
    v_pk_mul_f32 v[224:225], v[224:225], v[48:49] op_sel:[0,0] op_sel_hi:[1,0]
    v_pk_mul_f32 v[226:227], v[226:227], v[48:49] op_sel:[0,0] op_sel_hi:[1,0]
    v_pk_mul_f32 v[228:229], v[228:229], v[52:53] op_sel:[0,0] op_sel_hi:[1,0]
    v_pk_mul_f32 v[230:231], v[230:231], v[52:53] op_sel:[0,0] op_sel_hi:[1,0]
    v_cvt_pk_bf16_f32 v224, v224, v225
    v_cvt_pk_bf16_f32 v225, v226, v227
    v_cvt_pk_bf16_f32 v226, v228, v229
    v_cvt_pk_bf16_f32 v227, v230, v231
    buffer_store_dwordx4 v[224:227], v47, s[28:31], s71 offen offset:0 sc1
    v_pk_mul_f32 v[232:233], v[232:233], v[56:57] op_sel:[0,0] op_sel_hi:[1,0]
    v_pk_mul_f32 v[234:235], v[234:235], v[56:57] op_sel:[0,0] op_sel_hi:[1,0]
    v_pk_mul_f32 v[236:237], v[236:237], v[60:61] op_sel:[0,0] op_sel_hi:[1,0]
    v_pk_mul_f32 v[238:239], v[238:239], v[60:61] op_sel:[0,0] op_sel_hi:[1,0]
    v_cvt_pk_bf16_f32 v232, v232, v233
    v_cvt_pk_bf16_f32 v233, v234, v235
    v_cvt_pk_bf16_f32 v234, v236, v237
    v_cvt_pk_bf16_f32 v235, v238, v239
    buffer_store_dwordx4 v[232:235], v47, s[28:31], s71 offen offset:1024 sc1
K1_END:
    s_endpgm

.globl reduce_partials_kernel
.p2align 8
.type reduce_partials_kernel,@function
reduce_partials_kernel:
    s_cmp_ge_u32 s2, 896
    s_cbranch_scc1 K2_END
    s_load_dwordx2 s[4:5], s[0:1], 80
    s_load_dwordx2 s[6:7], s[0:1], 96
    s_mul_hi_u32 s3, s2, 0x4924925
    s_mul_i32 s8, s3, 56
    s_sub_u32 s8, s2, s8
    v_lshlrev_b32 v2, 4, v0
    s_lshl_b32 s9, s8, 10
    v_add_u32 v2, s9, v2
    s_mul_i32 s12, s3, 917504
    s_mov_b32 s24, 0
    s_mov_b32 s25, 57344
    s_mov_b32 s26, 114688
    s_mov_b32 s27, 172032
    s_mov_b32 s28, 229376
    s_mov_b32 s29, 286720
    s_mov_b32 s30, 344064
    s_mov_b32 s31, 401408
    s_mov_b32 s32, 458752
    s_mov_b32 s33, 516096
    s_mov_b32 s34, 573440
    s_mov_b32 s35, 630784
    s_mov_b32 s36, 688128
    s_mov_b32 s37, 745472
    s_mov_b32 s38, 802816
    s_mov_b32 s39, 860160
    s_mov_b32 s18, 917504
    s_mov_b32 s19, 0x00020000
    s_waitcnt lgkmcnt(0)
    s_add_u32 s16, s6, s12
    s_addc_u32 s17, s7, 0
    s_and_b32 s17, s17, 0xffff
    buffer_load_dwordx4 v[16:19], v2, s[16:19], s24 offen
    buffer_load_dwordx4 v[20:23], v2, s[16:19], s25 offen
    buffer_load_dwordx4 v[24:27], v2, s[16:19], s26 offen
    buffer_load_dwordx4 v[28:31], v2, s[16:19], s27 offen
    buffer_load_dwordx4 v[32:35], v2, s[16:19], s28 offen
    buffer_load_dwordx4 v[36:39], v2, s[16:19], s29 offen
    buffer_load_dwordx4 v[40:43], v2, s[16:19], s30 offen
    buffer_load_dwordx4 v[44:47], v2, s[16:19], s31 offen
    buffer_load_dwordx4 v[48:51], v2, s[16:19], s32 offen
    buffer_load_dwordx4 v[52:55], v2, s[16:19], s33 offen
    buffer_load_dwordx4 v[56:59], v2, s[16:19], s34 offen
    buffer_load_dwordx4 v[60:63], v2, s[16:19], s35 offen
    buffer_load_dwordx4 v[64:67], v2, s[16:19], s36 offen
    buffer_load_dwordx4 v[68:71], v2, s[16:19], s37 offen
    buffer_load_dwordx4 v[72:75], v2, s[16:19], s38 offen
    buffer_load_dwordx4 v[76:79], v2, s[16:19], s39 offen
    s_mul_i32 s9, s8, 4682
    s_lshr_b32 s9, s9, 16
    s_mul_i32 s13, s9, 14
    s_sub_u32 s13, s8, s13
    s_lshr_b32 s14, s13, 1
    s_and_b32 s13, s13, 1
    s_and_b32 s10, s3, 7
    s_lshr_b32 s11, s3, 3
    s_mul_i32 s10, s10, 114688
    s_mul_i32 s11, s11, 896
    s_add_u32 s10, s10, s11
    s_mul_i32 s11, s13, 57344
    s_add_u32 s10, s10, s11
    s_mul_i32 s11, s9, 224
    s_add_u32 s10, s10, s11
    s_lshl_b32 s11, s14, 5
    s_add_u32 s10, s10, s11
    v_and_b32 v3, 15, v0
    v_lshrrev_b32 v4, 4, v0
    v_mul_u32_u24 v3, 1792, v3
    v_lshl_add_u32 v3, v4, 3, v3
    v_add_u32 v3, s10, v3
    s_mov_b32 s15, 28672
    s_mov_b32 s20, s4
    s_and_b32 s21, s5, 0xffff
    s_mov_b32 s22, 917504
    s_mov_b32 s23, 0x00020000
    s_waitcnt vmcnt(15)
    v_lshlrev_b32 v8, 16, v16
    v_and_b32 v9, 0xffff0000, v16
    v_lshlrev_b32 v10, 16, v17
    v_and_b32 v11, 0xffff0000, v17
    v_lshlrev_b32 v12, 16, v18
    v_and_b32 v13, 0xffff0000, v18
    v_lshlrev_b32 v14, 16, v19
    v_and_b32 v15, 0xffff0000, v19
    s_waitcnt vmcnt(14)
    v_lshlrev_b32 v4, 16, v20
    v_and_b32 v5, 0xffff0000, v20
    v_pk_add_f32 v[8:9], v[8:9], v[4:5]
    v_lshlrev_b32 v6, 16, v21
    v_and_b32 v7, 0xffff0000, v21
    v_pk_add_f32 v[10:11], v[10:11], v[6:7]
    v_lshlrev_b32 v4, 16, v22
    v_and_b32 v5, 0xffff0000, v22
    v_pk_add_f32 v[12:13], v[12:13], v[4:5]
    v_lshlrev_b32 v6, 16, v23
    v_and_b32 v7, 0xffff0000, v23
    v_pk_add_f32 v[14:15], v[14:15], v[6:7]
    s_waitcnt vmcnt(13)
    v_lshlrev_b32 v4, 16, v24
    v_and_b32 v5, 0xffff0000, v24
    v_pk_add_f32 v[8:9], v[8:9], v[4:5]
    v_lshlrev_b32 v6, 16, v25
    v_and_b32 v7, 0xffff0000, v25
    v_pk_add_f32 v[10:11], v[10:11], v[6:7]
    v_lshlrev_b32 v4, 16, v26
    v_and_b32 v5, 0xffff0000, v26
    v_pk_add_f32 v[12:13], v[12:13], v[4:5]
    v_lshlrev_b32 v6, 16, v27
    v_and_b32 v7, 0xffff0000, v27
    v_pk_add_f32 v[14:15], v[14:15], v[6:7]
    s_waitcnt vmcnt(12)
    v_lshlrev_b32 v4, 16, v28
    v_and_b32 v5, 0xffff0000, v28
    v_pk_add_f32 v[8:9], v[8:9], v[4:5]
    v_lshlrev_b32 v6, 16, v29
    v_and_b32 v7, 0xffff0000, v29
    v_pk_add_f32 v[10:11], v[10:11], v[6:7]
    v_lshlrev_b32 v4, 16, v30
    v_and_b32 v5, 0xffff0000, v30
    v_pk_add_f32 v[12:13], v[12:13], v[4:5]
    v_lshlrev_b32 v6, 16, v31
    v_and_b32 v7, 0xffff0000, v31
    v_pk_add_f32 v[14:15], v[14:15], v[6:7]
    s_waitcnt vmcnt(11)
    v_lshlrev_b32 v4, 16, v32
    v_and_b32 v5, 0xffff0000, v32
    v_pk_add_f32 v[8:9], v[8:9], v[4:5]
    v_lshlrev_b32 v6, 16, v33
    v_and_b32 v7, 0xffff0000, v33
    v_pk_add_f32 v[10:11], v[10:11], v[6:7]
    v_lshlrev_b32 v4, 16, v34
    v_and_b32 v5, 0xffff0000, v34
    v_pk_add_f32 v[12:13], v[12:13], v[4:5]
    v_lshlrev_b32 v6, 16, v35
    v_and_b32 v7, 0xffff0000, v35
    v_pk_add_f32 v[14:15], v[14:15], v[6:7]
    s_waitcnt vmcnt(10)
    v_lshlrev_b32 v4, 16, v36
    v_and_b32 v5, 0xffff0000, v36
    v_pk_add_f32 v[8:9], v[8:9], v[4:5]
    v_lshlrev_b32 v6, 16, v37
    v_and_b32 v7, 0xffff0000, v37
    v_pk_add_f32 v[10:11], v[10:11], v[6:7]
    v_lshlrev_b32 v4, 16, v38
    v_and_b32 v5, 0xffff0000, v38
    v_pk_add_f32 v[12:13], v[12:13], v[4:5]
    v_lshlrev_b32 v6, 16, v39
    v_and_b32 v7, 0xffff0000, v39
    v_pk_add_f32 v[14:15], v[14:15], v[6:7]
    s_waitcnt vmcnt(9)
    v_lshlrev_b32 v4, 16, v40
    v_and_b32 v5, 0xffff0000, v40
    v_pk_add_f32 v[8:9], v[8:9], v[4:5]
    v_lshlrev_b32 v6, 16, v41
    v_and_b32 v7, 0xffff0000, v41
    v_pk_add_f32 v[10:11], v[10:11], v[6:7]
    v_lshlrev_b32 v4, 16, v42
    v_and_b32 v5, 0xffff0000, v42
    v_pk_add_f32 v[12:13], v[12:13], v[4:5]
    v_lshlrev_b32 v6, 16, v43
    v_and_b32 v7, 0xffff0000, v43
    v_pk_add_f32 v[14:15], v[14:15], v[6:7]
    s_waitcnt vmcnt(8)
    v_lshlrev_b32 v4, 16, v44
    v_and_b32 v5, 0xffff0000, v44
    v_pk_add_f32 v[8:9], v[8:9], v[4:5]
    v_lshlrev_b32 v6, 16, v45
    v_and_b32 v7, 0xffff0000, v45
    v_pk_add_f32 v[10:11], v[10:11], v[6:7]
    v_lshlrev_b32 v4, 16, v46
    v_and_b32 v5, 0xffff0000, v46
    v_pk_add_f32 v[12:13], v[12:13], v[4:5]
    v_lshlrev_b32 v6, 16, v47
    v_and_b32 v7, 0xffff0000, v47
    v_pk_add_f32 v[14:15], v[14:15], v[6:7]
    s_waitcnt vmcnt(7)
    v_lshlrev_b32 v4, 16, v48
    v_and_b32 v5, 0xffff0000, v48
    v_pk_add_f32 v[8:9], v[8:9], v[4:5]
    v_lshlrev_b32 v6, 16, v49
    v_and_b32 v7, 0xffff0000, v49
    v_pk_add_f32 v[10:11], v[10:11], v[6:7]
    v_lshlrev_b32 v4, 16, v50
    v_and_b32 v5, 0xffff0000, v50
    v_pk_add_f32 v[12:13], v[12:13], v[4:5]
    v_lshlrev_b32 v6, 16, v51
    v_and_b32 v7, 0xffff0000, v51
    v_pk_add_f32 v[14:15], v[14:15], v[6:7]
    s_waitcnt vmcnt(6)
    v_lshlrev_b32 v4, 16, v52
    v_and_b32 v5, 0xffff0000, v52
    v_pk_add_f32 v[8:9], v[8:9], v[4:5]
    v_lshlrev_b32 v6, 16, v53
    v_and_b32 v7, 0xffff0000, v53
    v_pk_add_f32 v[10:11], v[10:11], v[6:7]
    v_lshlrev_b32 v4, 16, v54
    v_and_b32 v5, 0xffff0000, v54
    v_pk_add_f32 v[12:13], v[12:13], v[4:5]
    v_lshlrev_b32 v6, 16, v55
    v_and_b32 v7, 0xffff0000, v55
    v_pk_add_f32 v[14:15], v[14:15], v[6:7]
    s_waitcnt vmcnt(5)
    v_lshlrev_b32 v4, 16, v56
    v_and_b32 v5, 0xffff0000, v56
    v_pk_add_f32 v[8:9], v[8:9], v[4:5]
    v_lshlrev_b32 v6, 16, v57
    v_and_b32 v7, 0xffff0000, v57
    v_pk_add_f32 v[10:11], v[10:11], v[6:7]
    v_lshlrev_b32 v4, 16, v58
    v_and_b32 v5, 0xffff0000, v58
    v_pk_add_f32 v[12:13], v[12:13], v[4:5]
    v_lshlrev_b32 v6, 16, v59
    v_and_b32 v7, 0xffff0000, v59
    v_pk_add_f32 v[14:15], v[14:15], v[6:7]
    s_waitcnt vmcnt(4)
    v_lshlrev_b32 v4, 16, v60
    v_and_b32 v5, 0xffff0000, v60
    v_pk_add_f32 v[8:9], v[8:9], v[4:5]
    v_lshlrev_b32 v6, 16, v61
    v_and_b32 v7, 0xffff0000, v61
    v_pk_add_f32 v[10:11], v[10:11], v[6:7]
    v_lshlrev_b32 v4, 16, v62
    v_and_b32 v5, 0xffff0000, v62
    v_pk_add_f32 v[12:13], v[12:13], v[4:5]
    v_lshlrev_b32 v6, 16, v63
    v_and_b32 v7, 0xffff0000, v63
    v_pk_add_f32 v[14:15], v[14:15], v[6:7]
    s_waitcnt vmcnt(3)
    v_lshlrev_b32 v4, 16, v64
    v_and_b32 v5, 0xffff0000, v64
    v_pk_add_f32 v[8:9], v[8:9], v[4:5]
    v_lshlrev_b32 v6, 16, v65
    v_and_b32 v7, 0xffff0000, v65
    v_pk_add_f32 v[10:11], v[10:11], v[6:7]
    v_lshlrev_b32 v4, 16, v66
    v_and_b32 v5, 0xffff0000, v66
    v_pk_add_f32 v[12:13], v[12:13], v[4:5]
    v_lshlrev_b32 v6, 16, v67
    v_and_b32 v7, 0xffff0000, v67
    v_pk_add_f32 v[14:15], v[14:15], v[6:7]
    s_waitcnt vmcnt(2)
    v_lshlrev_b32 v4, 16, v68
    v_and_b32 v5, 0xffff0000, v68
    v_pk_add_f32 v[8:9], v[8:9], v[4:5]
    v_lshlrev_b32 v6, 16, v69
    v_and_b32 v7, 0xffff0000, v69
    v_pk_add_f32 v[10:11], v[10:11], v[6:7]
    v_lshlrev_b32 v4, 16, v70
    v_and_b32 v5, 0xffff0000, v70
    v_pk_add_f32 v[12:13], v[12:13], v[4:5]
    v_lshlrev_b32 v6, 16, v71
    v_and_b32 v7, 0xffff0000, v71
    v_pk_add_f32 v[14:15], v[14:15], v[6:7]
    s_waitcnt vmcnt(1)
    v_lshlrev_b32 v4, 16, v72
    v_and_b32 v5, 0xffff0000, v72
    v_pk_add_f32 v[8:9], v[8:9], v[4:5]
    v_lshlrev_b32 v6, 16, v73
    v_and_b32 v7, 0xffff0000, v73
    v_pk_add_f32 v[10:11], v[10:11], v[6:7]
    v_lshlrev_b32 v4, 16, v74
    v_and_b32 v5, 0xffff0000, v74
    v_pk_add_f32 v[12:13], v[12:13], v[4:5]
    v_lshlrev_b32 v6, 16, v75
    v_and_b32 v7, 0xffff0000, v75
    v_pk_add_f32 v[14:15], v[14:15], v[6:7]
    s_waitcnt vmcnt(0)
    v_lshlrev_b32 v4, 16, v76
    v_and_b32 v5, 0xffff0000, v76
    v_pk_add_f32 v[8:9], v[8:9], v[4:5]
    v_lshlrev_b32 v6, 16, v77
    v_and_b32 v7, 0xffff0000, v77
    v_pk_add_f32 v[10:11], v[10:11], v[6:7]
    v_lshlrev_b32 v4, 16, v78
    v_and_b32 v5, 0xffff0000, v78
    v_pk_add_f32 v[12:13], v[12:13], v[4:5]
    v_lshlrev_b32 v6, 16, v79
    v_and_b32 v7, 0xffff0000, v79
    v_pk_add_f32 v[14:15], v[14:15], v[6:7]
    v_cvt_pk_bf16_f32 v4, v8, v9
    v_cvt_pk_bf16_f32 v5, v10, v11
    v_cvt_pk_bf16_f32 v6, v12, v13
    v_cvt_pk_bf16_f32 v7, v14, v15
    buffer_store_dwordx2 v[4:5], v3, s[20:23], 0 offen
    buffer_store_dwordx2 v[6:7], v3, s[20:23], s15 offen
K2_END:
    s_endpgm

CODE_END:
.fill 64, 4, 0xbf800000
.section .rodata,"a"
.p2align 6
.amdhsa_kernel concat_heads__gqa_block_cached__gqa_block_cached__near_ridge_kernel
  .amdhsa_next_free_vgpr 512
  .amdhsa_next_free_sgpr 102
  .amdhsa_accum_offset 256
  .amdhsa_group_segment_fixed_size 0
  .amdhsa_kernarg_size 104
  .amdhsa_user_sgpr_count 2
  .amdhsa_user_sgpr_kernarg_segment_ptr 1
  .amdhsa_system_sgpr_workgroup_id_x 1
.end_amdhsa_kernel

.p2align 6
.amdhsa_kernel reduce_partials_kernel
  .amdhsa_next_free_vgpr 80
  .amdhsa_next_free_sgpr 48
  .amdhsa_accum_offset 80
  .amdhsa_group_segment_fixed_size 0
  .amdhsa_kernarg_size 104
  .amdhsa_user_sgpr_count 2
  .amdhsa_user_sgpr_kernarg_segment_ptr 1
  .amdhsa_system_sgpr_workgroup_id_x 1
.end_amdhsa_kernel
```
